```python
import torch

def _softmax(x, axis=-1):
    return torch.softmax(x, dim=axis)
def _gelu(x):
    return torch.nn.functional.gelu(x, approximate="tanh")
def _silu(x):
    return torch.nn.functional.silu(x)
def _sigmoid(x):
    return torch.sigmoid(x)
def _layernorm(x, axis=-1, eps=1e-5):
    m = x.mean(dim=axis, keepdim=True)
    v = x.var(dim=axis, keepdim=True, unbiased=False)
    return (x - m) / torch.sqrt(v + eps)
def _scatter_add(tgt, idx, src, axis=0):
    return tgt.clone().index_add_(axis, idx, src)
def _segment_sum(src, seg, n):
    out = torch.zeros((n,) + src.shape[1:], dtype=src.dtype)
    return out.index_add_(0, seg, src)
def _pad(x, pw):
    flat = tuple(v for pair in reversed(pw) for v in pair)
    return torch.nn.functional.pad(x, flat)

kernel_name = 'standalone__mha_block_cached__near_ridge'

def setup_inputs():

    _w = (lambda a: (lambda t: t.to(torch.bfloat16) if t.is_floating_point() else t)(torch.as_tensor(a)))
    B, Sq, D = 8, 64, 640
    H, Sk, Dh = 32, 64, 192
    return {
        "x": _w((lambda *s: torch.randn(*s, dtype=torch.bfloat16) * 0.8)(B, Sq, D)),
        "k_cache": _w((lambda *s: torch.randn(*s, dtype=torch.bfloat16) * 0.8)(B, H, Sk, Dh)),
        "v_cache": _w((lambda *s: torch.randn(*s, dtype=torch.bfloat16) * 0.05)(B, H, Sk, Dh)),
        "wq": _w((lambda *s: torch.randn(*s, dtype=torch.bfloat16) * 0.8)(D, H * Dh) * (D ** -0.5)),
        "wo": _w((lambda *s: torch.randn(*s, dtype=torch.bfloat16) * 0.05)(H * Dh, D) * ((H * Dh) ** -0.5)),
    }

def reference(x, k_cache, v_cache, wq, wo):
    B, Sq, D = x.shape
    H, Dh = 32, 192
    q = (lambda x, *d: x.permute(*d))((x @ wq).reshape(B, Sq, H, Dh), 0, 2, 1, 3)
    scores = torch.einsum("bhqd,bhkd->bhqk", q, k_cache) * (Dh ** -0.5)
    p = _softmax(scores, axis=-1)
    o = torch.einsum("bhqk,bhkd->bhqd", p, v_cache)
    return (lambda x, *d: x.permute(*d))(o, 0, 2, 1, 3).reshape(B, Sq, H * Dh) @ wo
```

```asm
; @launch grid=(256,1,1) block=(512,1,1) lds=163840
.amdgcn_target "amdgcn-amd-amdhsa--gfx950"
.text
.globl standalone__mha_block_cached__near_ridge_kernel
.p2align 8
.type standalone__mha_block_cached__near_ridge_kernel,@function
standalone__mha_block_cached__near_ridge_kernel:
    s_cmp_ge_u32 s2, 256
    s_cbranch_scc1 L_end
    s_load_dwordx16 s[16:31], s[0:1], 0
    v_lshrrev_b32 v1, 6, v0
    v_and_b32 v2, 63, v0
    v_readfirstlane_b32 s3, v1
    s_and_b32 s4, s2, 7
    s_lshr_b32 s5, s2, 5
    s_bfe_u32 s7, s2, 0x20003
    s_lshl_b32 s6, s4, 2
    s_add_u32 s6, s6, s7
    s_mov_b32 s94, s7
    s_mul_i32 s61, s5, 5
    s_lshr_b32 s61, s61, 2
    s_mul_i32 s8, s7, 5
    s_lshr_b32 s8, s8, 1
    s_add_u32 s61, s61, s8
    s_cmp_ge_u32 s61, 10
    s_cselect_b32 s8, 10, 0
    s_sub_u32 s61, s61, s8
    s_lshl_b32 s61, s61, 1
    s_cmp_ge_u32 s3, 4
    s_cbranch_scc1 L_loaders
    s_setprio 3
    v_lshrrev_b32 v3, 4, v2
    v_and_b32 v4, 15, v2
    v_bfe_u32 v5, v2, 2, 2
    v_and_b32 v6, 3, v2
    v_lshlrev_b32 v7, 3, v3
    v_add_u32 v7, v7, v5
    v_mul_u32_u24 v7, 384, v7
    v_lshl_add_u32 v7, v6, 3, v7
    v_lshrrev_b32 v8, 1, v5
    v_and_b32 v9, 1, v3
    v_lshl_add_u32 v8, v9, 1, v8
    s_mul_i32 s9, s3, 3
    s_add_u32 s10, s9, 0
    v_xor_b32 v9, s10, v8
    v_lshl_add_u32 v10, v9, 5, v7
    s_add_u32 s10, s9, 1
    v_xor_b32 v9, s10, v8
    v_lshl_add_u32 v11, v9, 5, v7
    s_add_u32 s10, s9, 2
    v_xor_b32 v9, s10, v8
    v_lshl_add_u32 v12, v9, 5, v7
    v_lshrrev_b32 v8, 1, v4
    v_xor_b32 v8, v8, v3
    v_lshlrev_b32 v8, 4, v8
    v_lshl_add_u32 v13, v4, 7, v8
    v_add_u32 v13, 12288, v13
    v_xor_b32 v23, 64, v13
    v_and_b32 v8, 6, v4
    v_xor_b32 v8, v8, v3
    v_lshlrev_b32 v8, 4, v8
    v_mul_u32_u24 v9, 384, v4
    v_add_u32 v14, v8, v9
    v_xor_b32 v15, 64, v14
    s_mov_b32 s12, 131072
    s_mov_b32 s32, 147456
    v_add_u32 v16, s12, v10
    v_add_u32 v17, s12, v11
    v_add_u32 v18, s12, v12
    v_add_u32 v19, s12, v13
    v_add_u32 v20, s32, v13
    v_add_u32 v21, s12, v23
    v_add_u32 v22, s32, v23
    v_mov_b32 v56, 0
    v_mov_b32 v57, 0
    v_mov_b32 v58, 0
    v_mov_b32 v59, 0
    v_mov_b32 v60, 0
    v_mov_b32 v61, 0
    v_mov_b32 v62, 0
    v_mov_b32 v63, 0
    v_mov_b32 v64, 0
    v_mov_b32 v65, 0
    v_mov_b32 v66, 0
    v_mov_b32 v67, 0
    v_mov_b32 v68, 0
    v_mov_b32 v69, 0
    v_mov_b32 v70, 0
    v_mov_b32 v71, 0
    v_mov_b32 v72, 0
    v_mov_b32 v73, 0
    v_mov_b32 v74, 0
    v_mov_b32 v75, 0
    v_mov_b32 v76, 0
    v_mov_b32 v77, 0
    v_mov_b32 v78, 0
    v_mov_b32 v79, 0
    v_mov_b32 v80, 0
    v_mov_b32 v81, 0
    v_mov_b32 v82, 0
    v_mov_b32 v83, 0
    v_mov_b32 v84, 0
    v_mov_b32 v85, 0
    v_mov_b32 v86, 0
    v_mov_b32 v87, 0
    v_mov_b32 v88, 0
    v_mov_b32 v89, 0
    v_mov_b32 v90, 0
    v_mov_b32 v91, 0
    v_mov_b32 v92, 0
    v_mov_b32 v93, 0
    v_mov_b32 v94, 0
    v_mov_b32 v95, 0
    v_mov_b32 v96, 0
    v_mov_b32 v97, 0
    v_mov_b32 v98, 0
    v_mov_b32 v99, 0
    v_mov_b32 v100, 0
    v_mov_b32 v101, 0
    v_mov_b32 v102, 0
    v_mov_b32 v103, 0
    v_mov_b32 v132, 0
    v_mov_b32 v133, 0
    v_mov_b32 v134, 0
    v_mov_b32 v135, 0
    v_mov_b32 v136, 0
    v_mov_b32 v137, 0
    v_mov_b32 v138, 0
    v_mov_b32 v139, 0
    v_mov_b32 v140, 0
    v_mov_b32 v141, 0
    v_mov_b32 v142, 0
    v_mov_b32 v143, 0
    v_mov_b32 v144, 0
    v_mov_b32 v145, 0
    v_mov_b32 v146, 0
    v_mov_b32 v147, 0
    v_mov_b32 v148, 0
    v_mov_b32 v149, 0
    v_mov_b32 v150, 0
    v_mov_b32 v151, 0
    v_mov_b32 v152, 0
    v_mov_b32 v153, 0
    v_mov_b32 v154, 0
    v_mov_b32 v155, 0
    v_mov_b32 v156, 0
    v_mov_b32 v157, 0
    v_mov_b32 v158, 0
    v_mov_b32 v159, 0
    v_lshrrev_b32 v8, 1, v3
    v_and_b32 v9, 7, v4
    v_mul_u32_u24 v7, 384, v4
    v_and_b32 v1, 1, v3
    v_lshl_add_u32 v7, v1, 3, v7
    s_mul_i32 s9, s3, 6
    s_add_u32 s10, s9, 0
    v_add_u32 v1, s10, v8
    v_xor_b32 v1, v1, v9
    v_lshl_add_u32 v24, v1, 4, v7
    v_add_u32 v24, 49152, v24
    s_add_u32 s10, s9, 2
    v_add_u32 v1, s10, v8
    v_xor_b32 v1, v1, v9
    v_lshl_add_u32 v25, v1, 4, v7
    v_add_u32 v25, 49152, v25
    s_add_u32 s10, s9, 4
    v_add_u32 v1, s10, v8
    v_xor_b32 v1, v1, v9
    v_lshl_add_u32 v26, v1, 4, v7
    v_add_u32 v26, 49152, v26
    s_mul_i32 s9, s3, 6144
    s_add_u32 s9, s9, 73728
    v_add_u32 v7, s9, v7
    v_add_u32 v1, 0, v8
    v_xor_b32 v1, v1, v9
    v_lshl_add_u32 v31, v1, 4, v7
    v_add_u32 v1, 2, v8
    v_xor_b32 v1, v1, v9
    v_lshl_add_u32 v32, v1, 4, v7
    v_add_u32 v1, 4, v8
    v_xor_b32 v1, v1, v9
    v_lshl_add_u32 v33, v1, 4, v7
    v_add_u32 v1, 6, v8
    v_xor_b32 v1, v1, v9
    v_lshl_add_u32 v34, v1, 4, v7
    v_lshl_add_u32 v7, v3, 2, v5
    v_lshrrev_b32 v8, 1, v7
    v_and_b32 v8, 3, v8
    v_mul_u32_u24 v7, 384, v7
    v_lshl_add_u32 v7, v6, 3, v7
    v_add_u32 v7, 24576, v7
    v_xor_b32 v9, 0, v8
    v_lshl_add_u32 v27, v9, 5, v7
    v_xor_b32 v9, 1, v8
    v_lshl_add_u32 v28, v9, 5, v7
    v_xor_b32 v9, 2, v8
    v_lshl_add_u32 v29, v9, 5, v7
    v_xor_b32 v9, 3, v8
    v_lshl_add_u32 v30, v9, 5, v7
    s_and_b32 s8, s3, 1
    s_lshr_b32 s9, s3, 1
    s_mul_i32 s10, s8, 12288
    s_add_u32 s10, s10, 73728
    v_add_u32 v37, s10, v14
    v_xor_b32 v38, 64, v37
    v_lshl_add_u32 v7, v3, 3, v5
    v_mul_u32_u24 v7, 320, v7
    v_lshl_add_u32 v7, v6, 3, v7
    s_mul_i32 s10, s9, 160
    s_add_u32 s10, s10, 98304
    v_add_u32 v7, s10, v7
    v_and_b32 v8, 1, v3
    v_lshlrev_b32 v8, 5, v8
    v_add_u32 v35, v7, v8
    v_sub_u32 v36, v7, v8
    s_cmp_eq_u32 s9, 0
    s_cbranch_scc1 L_noswap
    v_mov_b32 v7, v35
    v_mov_b32 v35, v36
    v_mov_b32 v36, v7
L_noswap:
    s_mul_i32 s9, s3, 6144
    s_add_u32 s9, s9, 49152
    v_and_b32 v8, 7, v4
    v_xor_b32 v8, v8, v3
    v_lshlrev_b32 v8, 4, v8
    v_mul_u32_u24 v9, 384, v4
    v_add_u32 v39, v8, v9
    v_add_u32 v39, s9, v39
    v_xor_b32 v40, 64, v39
    s_mov_b32 s13, 9
    s_waitcnt lgkmcnt(0)
L_c1_loop:
    s_barrier
    v_mfma_f32_16x16x32_bf16 v[56:59], v[132:135], v[144:147], v[56:59]
    ds_read_b128 v[116:119], v19 offset:0
    v_mfma_f32_16x16x32_bf16 v[60:63], v[132:135], v[148:151], v[60:63]
    ds_read_b128 v[120:123], v19 offset:2048
    v_mfma_f32_16x16x32_bf16 v[64:67], v[132:135], v[152:155], v[64:67]
    ds_read_b128 v[124:127], v20 offset:0
    v_mfma_f32_16x16x32_bf16 v[68:71], v[132:135], v[156:159], v[68:71]
    ds_read_b128 v[128:131], v20 offset:2048
    v_mfma_f32_16x16x32_bf16 v[72:75], v[136:139], v[144:147], v[72:75]
    ds_read_b64_tr_b16 v[104:105], v16
    v_mfma_f32_16x16x32_bf16 v[76:79], v[136:139], v[148:151], v[76:79]
    ds_read_b64_tr_b16 v[106:107], v16 offset:1536
    v_mfma_f32_16x16x32_bf16 v[80:83], v[136:139], v[152:155], v[80:83]
    ds_read_b64_tr_b16 v[108:109], v17
    v_add_u32 v16, s32, v10
    v_mfma_f32_16x16x32_bf16 v[84:87], v[136:139], v[156:159], v[84:87]
    ds_read_b64_tr_b16 v[110:111], v17 offset:1536
    v_mfma_f32_16x16x32_bf16 v[88:91], v[140:143], v[144:147], v[88:91]
    ds_read_b64_tr_b16 v[112:113], v18
    v_add_u32 v17, s32, v11
    v_mfma_f32_16x16x32_bf16 v[92:95], v[140:143], v[148:151], v[92:95]
    ds_read_b64_tr_b16 v[114:115], v18 offset:1536
    v_mfma_f32_16x16x32_bf16 v[96:99], v[140:143], v[152:155], v[96:99]
    v_add_u32 v18, s32, v12
    v_mfma_f32_16x16x32_bf16 v[100:103], v[140:143], v[156:159], v[100:103]
    s_waitcnt lgkmcnt(0)
    v_mfma_f32_16x16x32_bf16 v[56:59], v[104:107], v[116:119], v[56:59]
    ds_read_b128 v[144:147], v21 offset:0
    s_add_u32 s12, s12, 32768
    s_cmp_ge_u32 s12, 163840
    v_mfma_f32_16x16x32_bf16 v[60:63], v[104:107], v[120:123], v[60:63]
    ds_read_b128 v[148:151], v21 offset:2048
    s_cselect_b32 s14, 114688, 0
    s_sub_u32 s12, s12, s14
    v_mfma_f32_16x16x32_bf16 v[64:67], v[104:107], v[124:127], v[64:67]
    ds_read_b128 v[152:155], v22 offset:0
    s_add_u32 s32, s32, 32768
    s_cmp_ge_u32 s32, 163840
    v_mfma_f32_16x16x32_bf16 v[68:71], v[104:107], v[128:131], v[68:71]
    ds_read_b128 v[156:159], v22 offset:2048
    s_cselect_b32 s14, 114688, 0
    s_sub_u32 s32, s32, s14
    v_mfma_f32_16x16x32_bf16 v[72:75], v[108:111], v[116:119], v[72:75]
    ds_read_b64_tr_b16 v[132:133], v16
    v_add_u32 v19, s12, v13
    v_add_u32 v20, s32, v13
    v_mfma_f32_16x16x32_bf16 v[76:79], v[108:111], v[120:123], v[76:79]
    ds_read_b64_tr_b16 v[134:135], v16 offset:1536
    v_add_u32 v21, s12, v23
    v_add_u32 v22, s32, v23
    v_mfma_f32_16x16x32_bf16 v[80:83], v[108:111], v[124:127], v[80:83]
    ds_read_b64_tr_b16 v[136:137], v17
    v_add_u32 v16, s12, v10
    v_mfma_f32_16x16x32_bf16 v[84:87], v[108:111], v[128:131], v[84:87]
    ds_read_b64_tr_b16 v[138:139], v17 offset:1536
    v_mfma_f32_16x16x32_bf16 v[88:91], v[112:115], v[116:119], v[88:91]
    ds_read_b64_tr_b16 v[140:141], v18
    v_add_u32 v17, s12, v11
    v_mfma_f32_16x16x32_bf16 v[92:95], v[112:115], v[120:123], v[92:95]
    ds_read_b64_tr_b16 v[142:143], v18 offset:1536
    s_sub_u32 s13, s13, 1
    v_mfma_f32_16x16x32_bf16 v[96:99], v[112:115], v[124:127], v[96:99]
    v_add_u32 v18, s12, v12
    v_mfma_f32_16x16x32_bf16 v[100:103], v[112:115], v[128:131], v[100:103]
    s_cmp_lg_u32 s13, 0
    s_waitcnt lgkmcnt(0)
    s_cbranch_scc1 L_c1_loop
    s_barrier
    v_mfma_f32_16x16x32_bf16 v[56:59], v[132:135], v[144:147], v[56:59]
    ds_read_b128 v[116:119], v19 offset:0
    v_mfma_f32_16x16x32_bf16 v[60:63], v[132:135], v[148:151], v[60:63]
    ds_read_b128 v[120:123], v19 offset:2048
    v_mfma_f32_16x16x32_bf16 v[64:67], v[132:135], v[152:155], v[64:67]
    ds_read_b128 v[124:127], v20 offset:0
    v_mfma_f32_16x16x32_bf16 v[68:71], v[132:135], v[156:159], v[68:71]
    ds_read_b128 v[128:131], v20 offset:2048
    v_mfma_f32_16x16x32_bf16 v[72:75], v[136:139], v[144:147], v[72:75]
    ds_read_b64_tr_b16 v[104:105], v16
    v_mfma_f32_16x16x32_bf16 v[76:79], v[136:139], v[148:151], v[76:79]
    ds_read_b64_tr_b16 v[106:107], v16 offset:1536
    v_mfma_f32_16x16x32_bf16 v[80:83], v[136:139], v[152:155], v[80:83]
    ds_read_b64_tr_b16 v[108:109], v17
    v_add_u32 v16, s32, v10
    v_mfma_f32_16x16x32_bf16 v[84:87], v[136:139], v[156:159], v[84:87]
    ds_read_b64_tr_b16 v[110:111], v17 offset:1536
    v_mfma_f32_16x16x32_bf16 v[88:91], v[140:143], v[144:147], v[88:91]
    ds_read_b64_tr_b16 v[112:113], v18
    v_add_u32 v17, s32, v11
    v_mfma_f32_16x16x32_bf16 v[92:95], v[140:143], v[148:151], v[92:95]
    ds_read_b64_tr_b16 v[114:115], v18 offset:1536
    v_mfma_f32_16x16x32_bf16 v[96:99], v[140:143], v[152:155], v[96:99]
    v_add_u32 v18, s32, v12
    v_mfma_f32_16x16x32_bf16 v[100:103], v[140:143], v[156:159], v[100:103]
    s_waitcnt lgkmcnt(0)
    v_mfma_f32_16x16x32_bf16 v[56:59], v[104:107], v[116:119], v[56:59]
    ds_read_b128 v[144:147], v21 offset:0
    v_mfma_f32_16x16x32_bf16 v[60:63], v[104:107], v[120:123], v[60:63]
    ds_read_b128 v[148:151], v21 offset:2048
    v_mfma_f32_16x16x32_bf16 v[64:67], v[104:107], v[124:127], v[64:67]
    ds_read_b128 v[152:155], v22 offset:0
    v_mfma_f32_16x16x32_bf16 v[68:71], v[104:107], v[128:131], v[68:71]
    ds_read_b128 v[156:159], v22 offset:2048
    v_mfma_f32_16x16x32_bf16 v[72:75], v[108:111], v[116:119], v[72:75]
    ds_read_b64_tr_b16 v[132:133], v16
    v_mfma_f32_16x16x32_bf16 v[76:79], v[108:111], v[120:123], v[76:79]
    ds_read_b64_tr_b16 v[134:135], v16 offset:1536
    v_mfma_f32_16x16x32_bf16 v[80:83], v[108:111], v[124:127], v[80:83]
    ds_read_b64_tr_b16 v[136:137], v17
    v_mfma_f32_16x16x32_bf16 v[84:87], v[108:111], v[128:131], v[84:87]
    ds_read_b64_tr_b16 v[138:139], v17 offset:1536
    v_mfma_f32_16x16x32_bf16 v[88:91], v[112:115], v[116:119], v[88:91]
    ds_read_b64_tr_b16 v[140:141], v18
    v_mfma_f32_16x16x32_bf16 v[92:95], v[112:115], v[120:123], v[92:95]
    ds_read_b64_tr_b16 v[142:143], v18 offset:1536
    v_mfma_f32_16x16x32_bf16 v[96:99], v[112:115], v[124:127], v[96:99]
    v_mfma_f32_16x16x32_bf16 v[100:103], v[112:115], v[128:131], v[100:103]
    s_waitcnt lgkmcnt(0)
    v_mfma_f32_16x16x32_bf16 v[56:59], v[132:135], v[144:147], v[56:59]
    v_mfma_f32_16x16x32_bf16 v[60:63], v[132:135], v[148:151], v[60:63]
    v_mfma_f32_16x16x32_bf16 v[64:67], v[132:135], v[152:155], v[64:67]
    v_mfma_f32_16x16x32_bf16 v[68:71], v[132:135], v[156:159], v[68:71]
    v_mfma_f32_16x16x32_bf16 v[72:75], v[136:139], v[144:147], v[72:75]
    s_nop 3
    v_cvt_pk_bf16_f32 v42, v56, v57
    v_cvt_pk_bf16_f32 v43, v58, v59
    ds_write_b64 v24, v[42:43] offset:0
    v_mfma_f32_16x16x32_bf16 v[76:79], v[136:139], v[148:151], v[76:79]
    v_cvt_pk_bf16_f32 v44, v60, v61
    v_cvt_pk_bf16_f32 v45, v62, v63
    ds_write_b64 v24, v[44:45] offset:6144
    v_mfma_f32_16x16x32_bf16 v[80:83], v[136:139], v[152:155], v[80:83]
    v_cvt_pk_bf16_f32 v42, v64, v65
    v_cvt_pk_bf16_f32 v43, v66, v67
    ds_write_b64 v24, v[42:43] offset:12288
    v_mfma_f32_16x16x32_bf16 v[84:87], v[136:139], v[156:159], v[84:87]
    v_cvt_pk_bf16_f32 v44, v68, v69
    v_cvt_pk_bf16_f32 v45, v70, v71
    ds_write_b64 v24, v[44:45] offset:18432
    v_mfma_f32_16x16x32_bf16 v[88:91], v[140:143], v[144:147], v[88:91]
    v_cvt_pk_bf16_f32 v42, v72, v73
    v_cvt_pk_bf16_f32 v43, v74, v75
    ds_write_b64 v25, v[42:43] offset:0
    v_mfma_f32_16x16x32_bf16 v[92:95], v[140:143], v[148:151], v[92:95]
    v_cvt_pk_bf16_f32 v44, v76, v77
    v_cvt_pk_bf16_f32 v45, v78, v79
    ds_write_b64 v25, v[44:45] offset:6144
    v_mfma_f32_16x16x32_bf16 v[96:99], v[140:143], v[152:155], v[96:99]
    v_cvt_pk_bf16_f32 v42, v80, v81
    v_cvt_pk_bf16_f32 v43, v82, v83
    ds_write_b64 v25, v[42:43] offset:12288
    v_mfma_f32_16x16x32_bf16 v[100:103], v[140:143], v[156:159], v[100:103]
    v_cvt_pk_bf16_f32 v44, v84, v85
    v_cvt_pk_bf16_f32 v45, v86, v87
    ds_write_b64 v25, v[44:45] offset:18432
    s_nop 1
    v_cvt_pk_bf16_f32 v42, v88, v89
    v_cvt_pk_bf16_f32 v43, v90, v91
    ds_write_b64 v26, v[42:43] offset:0
    v_cvt_pk_bf16_f32 v44, v92, v93
    v_cvt_pk_bf16_f32 v45, v94, v95
    ds_write_b64 v26, v[44:45] offset:6144
    v_cvt_pk_bf16_f32 v42, v96, v97
    v_cvt_pk_bf16_f32 v43, v98, v99
    ds_write_b64 v26, v[42:43] offset:12288
    v_cvt_pk_bf16_f32 v44, v100, v101
    v_cvt_pk_bf16_f32 v45, v102, v103
    ds_write_b64 v26, v[44:45] offset:18432
    ds_read_b128 v[104:107], v14 offset:0
    ds_read_b128 v[108:111], v14 offset:6144
    ds_read_b128 v[112:115], v14 offset:12288
    ds_read_b128 v[116:119], v14 offset:18432
    ds_read_b128 v[120:123], v15 offset:0
    ds_read_b128 v[124:127], v15 offset:6144
    ds_read_b128 v[128:131], v15 offset:12288
    ds_read_b128 v[132:135], v15 offset:18432
    ds_read_b128 v[136:139], v14 offset:128
    ds_read_b128 v[140:143], v14 offset:6272
    ds_read_b128 v[144:147], v14 offset:12416
    ds_read_b128 v[148:151], v14 offset:18560
    s_waitcnt lgkmcnt(12)
    s_barrier
    v_mov_b32 v46, 159744
    ds_read_b128 v[56:59], v39 offset:0
    ds_read_b128 v[60:63], v40 offset:0
    ds_read_b128 v[64:67], v39 offset:128
    ds_read_b128 v[68:71], v40 offset:128
    ds_read_b128 v[72:75], v39 offset:256
    ds_read_b128 v[76:79], v40 offset:256
    ds_read_b96 v[48:50], v46
    s_waitcnt lgkmcnt(6)
    v_mfma_f32_16x16x32_bf16 v[80:83], v[104:107], v[56:59], 0
    v_mfma_f32_16x16x32_bf16 v[84:87], v[108:111], v[56:59], 0
    v_mfma_f32_16x16x32_bf16 v[88:91], v[112:115], v[56:59], 0
    v_mfma_f32_16x16x32_bf16 v[92:95], v[116:119], v[56:59], 0
    ds_read_b128 v[104:107], v15 offset:128
    ds_read_b128 v[108:111], v15 offset:6272
    ds_read_b128 v[112:115], v15 offset:12416
    ds_read_b128 v[116:119], v15 offset:18560
    s_waitcnt lgkmcnt(9)
    v_mfma_f32_16x16x32_bf16 v[80:83], v[120:123], v[60:63], v[80:83]
    v_mfma_f32_16x16x32_bf16 v[84:87], v[124:127], v[60:63], v[84:87]
    v_mfma_f32_16x16x32_bf16 v[88:91], v[128:131], v[60:63], v[88:91]
    v_mfma_f32_16x16x32_bf16 v[92:95], v[132:135], v[60:63], v[92:95]
    ds_read_b128 v[120:123], v14 offset:256
    ds_read_b128 v[124:127], v14 offset:6400
    ds_read_b128 v[128:131], v14 offset:12544
    ds_read_b128 v[132:135], v14 offset:18688
    s_waitcnt lgkmcnt(12)
    v_mfma_f32_16x16x32_bf16 v[80:83], v[136:139], v[64:67], v[80:83]
    v_mfma_f32_16x16x32_bf16 v[84:87], v[140:143], v[64:67], v[84:87]
    v_mfma_f32_16x16x32_bf16 v[88:91], v[144:147], v[64:67], v[88:91]
    v_mfma_f32_16x16x32_bf16 v[92:95], v[148:151], v[64:67], v[92:95]
    ds_read_b128 v[136:139], v15 offset:256
    ds_read_b128 v[140:143], v15 offset:6400
    ds_read_b128 v[144:147], v15 offset:12544
    ds_read_b128 v[148:151], v15 offset:18688
    s_waitcnt lgkmcnt(8)
    v_mfma_f32_16x16x32_bf16 v[80:83], v[104:107], v[68:71], v[80:83]
    v_mfma_f32_16x16x32_bf16 v[84:87], v[108:111], v[68:71], v[84:87]
    v_mfma_f32_16x16x32_bf16 v[88:91], v[112:115], v[68:71], v[88:91]
    v_mfma_f32_16x16x32_bf16 v[92:95], v[116:119], v[68:71], v[92:95]
    s_waitcnt lgkmcnt(4)
    v_mfma_f32_16x16x32_bf16 v[80:83], v[120:123], v[72:75], v[80:83]
    v_mfma_f32_16x16x32_bf16 v[84:87], v[124:127], v[72:75], v[84:87]
    v_mfma_f32_16x16x32_bf16 v[88:91], v[128:131], v[72:75], v[88:91]
    v_mfma_f32_16x16x32_bf16 v[92:95], v[132:135], v[72:75], v[92:95]
    s_waitcnt lgkmcnt(0)
    v_mfma_f32_16x16x32_bf16 v[80:83], v[136:139], v[76:79], v[80:83]
    v_mfma_f32_16x16x32_bf16 v[84:87], v[140:143], v[76:79], v[84:87]
    v_mfma_f32_16x16x32_bf16 v[88:91], v[144:147], v[76:79], v[88:91]
    v_mfma_f32_16x16x32_bf16 v[92:95], v[148:151], v[76:79], v[92:95]
    v_readfirstlane_b32 s52, v48
    v_readfirstlane_b32 s53, v49
    v_readfirstlane_b32 s54, v50
    s_lshl_b32 s8, s5, 5
    s_add_u32 s8, s8, s6
    s_lshl_b32 s8, s8, 13
    s_add_u32 s8, s8, 0
    s_add_u32 s48, s30, s8
    s_addc_u32 s49, s31, 0
    s_mov_b32 s50, 8192
    s_mov_b32 s51, 0x20000
    v_max3_f32 v8, v80, v81, v82
    v_max3_f32 v9, v83, v84, v85
    v_max3_f32 v8, v8, v86, v87
    v_max3_f32 v9, v9, v88, v89
    v_max3_f32 v8, v8, v90, v91
    v_max3_f32 v9, v9, v92, v93
    v_max3_f32 v8, v8, v94, v95
    v_max_f32 v8, v8, v9
    v_mov_b32 v9, v8
    s_mov_b32 s9, 0x3dd53b95
    s_nop 0
    v_permlane16_swap_b32 v8, v9
    v_max_f32 v8, v8, v9
    v_mov_b32 v9, v8
    s_nop 1
    v_permlane32_swap_b32 v8, v9
    v_max_f32 v8, v8, v9
    v_mul_f32 v8, s9, v8
    v_fma_f32 v80, v80, s9, -v8
    v_fma_f32 v81, v81, s9, -v8
    v_fma_f32 v82, v82, s9, -v8
    v_fma_f32 v83, v83, s9, -v8
    v_fma_f32 v84, v84, s9, -v8
    v_fma_f32 v85, v85, s9, -v8
    v_fma_f32 v86, v86, s9, -v8
    v_fma_f32 v87, v87, s9, -v8
    v_fma_f32 v88, v88, s9, -v8
    v_fma_f32 v89, v89, s9, -v8
    v_fma_f32 v90, v90, s9, -v8
    v_fma_f32 v91, v91, s9, -v8
    v_fma_f32 v92, v92, s9, -v8
    v_fma_f32 v93, v93, s9, -v8
    v_fma_f32 v94, v94, s9, -v8
    v_fma_f32 v95, v95, s9, -v8
    v_exp_f32 v80, v80
    v_exp_f32 v81, v81
    v_exp_f32 v82, v82
    v_exp_f32 v83, v83
    v_exp_f32 v84, v84
    v_exp_f32 v85, v85
    v_exp_f32 v86, v86
    v_exp_f32 v87, v87
    v_exp_f32 v88, v88
    v_exp_f32 v89, v89
    v_exp_f32 v90, v90
    v_exp_f32 v91, v91
    v_exp_f32 v92, v92
    v_exp_f32 v93, v93
    v_exp_f32 v94, v94
    v_exp_f32 v95, v95
    s_nop 0
    v_add_f32 v8, v80, v81
    v_add_f32 v9, v82, v83
    v_add_f32 v8, v8, v84
    v_add_f32 v9, v9, v85
    v_add_f32 v8, v8, v86
    v_add_f32 v9, v9, v87
    v_add_f32 v8, v8, v88
    v_add_f32 v9, v9, v89
    v_add_f32 v8, v8, v90
    v_add_f32 v9, v9, v91
    v_add_f32 v8, v8, v92
    v_add_f32 v9, v9, v93
    v_add_f32 v8, v8, v94
    v_add_f32 v9, v9, v95
    v_add_f32 v8, v8, v9
    v_mov_b32 v9, v8
    s_nop 1
    v_permlane16_swap_b32 v8, v9
    v_add_f32 v8, v8, v9
    v_mov_b32 v9, v8
    s_nop 1
    v_permlane32_swap_b32 v8, v9
    v_add_f32 v8, v8, v9
    v_rcp_f32 v8, v8
    s_nop 0
    v_mul_f32 v80, v80, v8
    v_mul_f32 v81, v81, v8
    v_mul_f32 v82, v82, v8
    v_mul_f32 v83, v83, v8
    v_mul_f32 v84, v84, v8
    v_mul_f32 v85, v85, v8
    v_mul_f32 v86, v86, v8
    v_mul_f32 v87, v87, v8
    v_mul_f32 v88, v88, v8
    v_mul_f32 v89, v89, v8
    v_mul_f32 v90, v90, v8
    v_mul_f32 v91, v91, v8
    v_mul_f32 v92, v92, v8
    v_mul_f32 v93, v93, v8
    v_mul_f32 v94, v94, v8
    v_mul_f32 v95, v95, v8
    v_cvt_pk_bf16_f32 v96, v80, v81
    v_cvt_pk_bf16_f32 v97, v82, v83
    v_cvt_pk_bf16_f32 v98, v84, v85
    v_cvt_pk_bf16_f32 v99, v86, v87
    v_cvt_pk_bf16_f32 v100, v88, v89
    v_cvt_pk_bf16_f32 v101, v90, v91
    v_cvt_pk_bf16_f32 v102, v92, v93
    v_cvt_pk_bf16_f32 v103, v94, v95
    s_lshl_b32 s9, s3, 11
    v_lshlrev_b32 v7, 4, v2
    buffer_store_dwordx4 v[96:99], v7, s[48:51], s9 offen sc1
    buffer_store_dwordx4 v[100:103], v7, s[48:51], s9 offen offset:1024 sc1
    s_lshl_b32 s8, s5, 3
    s_add_u32 s8, s8, s4
    s_lshl_b32 s8, s8, 7
    s_add_u32 s8, s8, 33554432
    s_add_u32 s40, s30, s8
    s_addc_u32 s41, s31, 0
    s_mov_b32 s42, 128
    s_mov_b32 s43, 0x20000
    s_lshl_b32 s8, s7, 2
    s_add_u32 s8, s8, s3
    s_lshl_b32 s8, s8, 3
    v_mov_b32 v51, s8
    v_mov_b32 v124, 0
    v_mov_b32 v125, 0
    v_mov_b32 v126, 0
    v_mov_b32 v127, 0
    v_mov_b32 v128, 0
    v_mov_b32 v129, 0
    v_mov_b32 v130, 0
    v_mov_b32 v131, 0
    v_mov_b32 v132, 0
    v_mov_b32 v133, 0
    v_mov_b32 v134, 0
    v_mov_b32 v135, 0
    v_mov_b32 v136, 0
    v_mov_b32 v137, 0
    v_mov_b32 v138, 0
    v_mov_b32 v139, 0
    v_mov_b32 v140, 0
    v_mov_b32 v141, 0
    v_mov_b32 v142, 0
    v_mov_b32 v143, 0
    v_mov_b32 v144, 0
    v_mov_b32 v145, 0
    v_mov_b32 v146, 0
    v_mov_b32 v147, 0
    v_mov_b32 v148, 0
    v_mov_b32 v149, 0
    v_mov_b32 v150, 0
    v_mov_b32 v151, 0
    v_subrev_u32 v39, 73728, v37
    v_subrev_u32 v40, 73728, v38
    s_barrier
    v_add_u32 v37, 24576, v39
    v_add_u32 v38, 24576, v40
    ds_read_b128 v[116:119], v37 offset:0
    ds_read_b128 v[120:123], v37 offset:6144
    ds_read_b64_tr_b16 v[96:97], v35 offset:20480
    ds_read_b64_tr_b16 v[98:99], v35 offset:21760
    ds_read_b64_tr_b16 v[100:101], v36 offset:20512
    ds_read_b64_tr_b16 v[102:103], v36 offset:21792
    ds_read_b64_tr_b16 v[104:105], v35 offset:20544
    ds_read_b64_tr_b16 v[106:107], v35 offset:21824
    ds_read_b64_tr_b16 v[108:109], v36 offset:20576
    ds_read_b64_tr_b16 v[110:111], v36 offset:21856
    ds_read_b64_tr_b16 v[112:113], v35 offset:20608
    ds_read_b64_tr_b16 v[114:115], v35 offset:21888
    s_waitcnt lgkmcnt(0)
    v_mfma_f32_16x16x32_bf16 v[56:59], v[116:119], v[96:99], 0
    ds_read_b128 v[144:147], v38 offset:0
    ds_read_b128 v[148:151], v38 offset:6144
    v_mfma_f32_16x16x32_bf16 v[60:63], v[120:123], v[96:99], 0
    ds_read_b64_tr_b16 v[124:125], v35 offset:30720
    ds_read_b64_tr_b16 v[126:127], v35 offset:32000
    v_mfma_f32_16x16x32_bf16 v[64:67], v[116:119], v[100:103], 0
    ds_read_b64_tr_b16 v[128:129], v36 offset:30752
    ds_read_b64_tr_b16 v[130:131], v36 offset:32032
    v_mfma_f32_16x16x32_bf16 v[68:71], v[120:123], v[100:103], 0
    ds_read_b64_tr_b16 v[132:133], v35 offset:30784
    v_mfma_f32_16x16x32_bf16 v[72:75], v[116:119], v[104:107], 0
    ds_read_b64_tr_b16 v[134:135], v35 offset:32064
    v_mfma_f32_16x16x32_bf16 v[76:79], v[120:123], v[104:107], 0
    ds_read_b64_tr_b16 v[136:137], v36 offset:30816
    v_mfma_f32_16x16x32_bf16 v[80:83], v[116:119], v[108:111], 0
    ds_read_b64_tr_b16 v[138:139], v36 offset:32096
    v_mfma_f32_16x16x32_bf16 v[84:87], v[120:123], v[108:111], 0
    ds_read_b64_tr_b16 v[140:141], v35 offset:30848
    v_mfma_f32_16x16x32_bf16 v[88:91], v[116:119], v[112:115], 0
    ds_read_b64_tr_b16 v[142:143], v35 offset:32128
    v_mfma_f32_16x16x32_bf16 v[92:95], v[120:123], v[112:115], 0
    s_waitcnt lgkmcnt(0)
    s_barrier
    v_mfma_f32_16x16x32_bf16 v[56:59], v[144:147], v[124:127], v[56:59]
    ds_read_b128 v[116:119], v37 offset:128
    ds_read_b128 v[120:123], v37 offset:6272
    v_mfma_f32_16x16x32_bf16 v[60:63], v[148:151], v[124:127], v[60:63]
    ds_read_b64_tr_b16 v[96:97], v35 offset:40960
    ds_read_b64_tr_b16 v[98:99], v35 offset:42240
    v_mfma_f32_16x16x32_bf16 v[64:67], v[144:147], v[128:131], v[64:67]
    ds_read_b64_tr_b16 v[100:101], v36 offset:40992
    ds_read_b64_tr_b16 v[102:103], v36 offset:42272
    v_mfma_f32_16x16x32_bf16 v[68:71], v[148:151], v[128:131], v[68:71]
    ds_read_b64_tr_b16 v[104:105], v35 offset:41024
    v_mfma_f32_16x16x32_bf16 v[72:75], v[144:147], v[132:135], v[72:75]
    ds_read_b64_tr_b16 v[106:107], v35 offset:42304
    v_mfma_f32_16x16x32_bf16 v[76:79], v[148:151], v[132:135], v[76:79]
    ds_read_b64_tr_b16 v[108:109], v36 offset:41056
    v_mfma_f32_16x16x32_bf16 v[80:83], v[144:147], v[136:139], v[80:83]
    ds_read_b64_tr_b16 v[110:111], v36 offset:42336
    v_mfma_f32_16x16x32_bf16 v[84:87], v[148:151], v[136:139], v[84:87]
    ds_read_b64_tr_b16 v[112:113], v35 offset:41088
    v_mfma_f32_16x16x32_bf16 v[88:91], v[144:147], v[140:143], v[88:91]
    ds_read_b64_tr_b16 v[114:115], v35 offset:42368
    v_mfma_f32_16x16x32_bf16 v[92:95], v[148:151], v[140:143], v[92:95]
    s_waitcnt lgkmcnt(0)
    v_mfma_f32_16x16x32_bf16 v[56:59], v[116:119], v[96:99], v[56:59]
    ds_read_b128 v[144:147], v38 offset:128
    ds_read_b128 v[148:151], v38 offset:6272
    v_mfma_f32_16x16x32_bf16 v[60:63], v[120:123], v[96:99], v[60:63]
    ds_read_b64_tr_b16 v[124:125], v35 offset:51200
    ds_read_b64_tr_b16 v[126:127], v35 offset:52480
    v_mfma_f32_16x16x32_bf16 v[64:67], v[116:119], v[100:103], v[64:67]
    ds_read_b64_tr_b16 v[128:129], v36 offset:51232
    ds_read_b64_tr_b16 v[130:131], v36 offset:52512
    v_mfma_f32_16x16x32_bf16 v[68:71], v[120:123], v[100:103], v[68:71]
    ds_read_b64_tr_b16 v[132:133], v35 offset:51264
    v_mfma_f32_16x16x32_bf16 v[72:75], v[116:119], v[104:107], v[72:75]
    ds_read_b64_tr_b16 v[134:135], v35 offset:52544
    v_mfma_f32_16x16x32_bf16 v[76:79], v[120:123], v[104:107], v[76:79]
    ds_read_b64_tr_b16 v[136:137], v36 offset:51296
    v_mfma_f32_16x16x32_bf16 v[80:83], v[116:119], v[108:111], v[80:83]
    ds_read_b64_tr_b16 v[138:139], v36 offset:52576
    v_mfma_f32_16x16x32_bf16 v[84:87], v[120:123], v[108:111], v[84:87]
    ds_read_b64_tr_b16 v[140:141], v35 offset:51328
    v_mfma_f32_16x16x32_bf16 v[88:91], v[116:119], v[112:115], v[88:91]
    ds_read_b64_tr_b16 v[142:143], v35 offset:52608
    v_mfma_f32_16x16x32_bf16 v[92:95], v[120:123], v[112:115], v[92:95]
    s_waitcnt lgkmcnt(0)
    s_barrier
    v_mfma_f32_16x16x32_bf16 v[56:59], v[144:147], v[124:127], v[56:59]
    ds_read_b128 v[116:119], v37 offset:256
    ds_read_b128 v[120:123], v37 offset:6400
    v_mfma_f32_16x16x32_bf16 v[60:63], v[148:151], v[124:127], v[60:63]
    ds_read_b64_tr_b16 v[96:97], v35 offset:0
    ds_read_b64_tr_b16 v[98:99], v35 offset:1280
    v_mfma_f32_16x16x32_bf16 v[64:67], v[144:147], v[128:131], v[64:67]
    ds_read_b64_tr_b16 v[100:101], v36 offset:32
    ds_read_b64_tr_b16 v[102:103], v36 offset:1312
    v_mfma_f32_16x16x32_bf16 v[68:71], v[148:151], v[128:131], v[68:71]
    ds_read_b64_tr_b16 v[104:105], v35 offset:64
    v_mfma_f32_16x16x32_bf16 v[72:75], v[144:147], v[132:135], v[72:75]
    ds_read_b64_tr_b16 v[106:107], v35 offset:1344
    v_mfma_f32_16x16x32_bf16 v[76:79], v[148:151], v[132:135], v[76:79]
    ds_read_b64_tr_b16 v[108:109], v36 offset:96
    v_mfma_f32_16x16x32_bf16 v[80:83], v[144:147], v[136:139], v[80:83]
    ds_read_b64_tr_b16 v[110:111], v36 offset:1376
    v_mfma_f32_16x16x32_bf16 v[84:87], v[148:151], v[136:139], v[84:87]
    ds_read_b64_tr_b16 v[112:113], v35 offset:128
    v_mfma_f32_16x16x32_bf16 v[88:91], v[144:147], v[140:143], v[88:91]
    ds_read_b64_tr_b16 v[114:115], v35 offset:1408
    v_mfma_f32_16x16x32_bf16 v[92:95], v[148:151], v[140:143], v[92:95]
    s_waitcnt lgkmcnt(0)
    v_mfma_f32_16x16x32_bf16 v[56:59], v[116:119], v[96:99], v[56:59]
    ds_read_b128 v[144:147], v38 offset:256
    ds_read_b128 v[148:151], v38 offset:6400
    v_mfma_f32_16x16x32_bf16 v[60:63], v[120:123], v[96:99], v[60:63]
    ds_read_b64_tr_b16 v[124:125], v35 offset:10240
    ds_read_b64_tr_b16 v[126:127], v35 offset:11520
    v_mfma_f32_16x16x32_bf16 v[64:67], v[116:119], v[100:103], v[64:67]
    ds_read_b64_tr_b16 v[128:129], v36 offset:10272
    ds_read_b64_tr_b16 v[130:131], v36 offset:11552
    v_mfma_f32_16x16x32_bf16 v[68:71], v[120:123], v[100:103], v[68:71]
    ds_read_b64_tr_b16 v[132:133], v35 offset:10304
    v_mfma_f32_16x16x32_bf16 v[72:75], v[116:119], v[104:107], v[72:75]
    ds_read_b64_tr_b16 v[134:135], v35 offset:11584
    v_mfma_f32_16x16x32_bf16 v[76:79], v[120:123], v[104:107], v[76:79]
    ds_read_b64_tr_b16 v[136:137], v36 offset:10336
    v_mfma_f32_16x16x32_bf16 v[80:83], v[116:119], v[108:111], v[80:83]
    ds_read_b64_tr_b16 v[138:139], v36 offset:11616
    v_mfma_f32_16x16x32_bf16 v[84:87], v[120:123], v[108:111], v[84:87]
    ds_read_b64_tr_b16 v[140:141], v35 offset:10368
    v_mfma_f32_16x16x32_bf16 v[88:91], v[116:119], v[112:115], v[88:91]
    ds_read_b64_tr_b16 v[142:143], v35 offset:11648
    v_mfma_f32_16x16x32_bf16 v[92:95], v[120:123], v[112:115], v[92:95]
    s_waitcnt vmcnt(0)
    s_mov_b64 exec, 1
    s_cmp_eq_u32 s54, 1
    s_cbranch_scc1 L_f1_fast
    buffer_store_dwordx2 v[48:49], v51, s[40:43], 0 offen sc1
    s_branch L_f1_done
L_f1_fast:
    buffer_store_dwordx2 v[48:49], v51, s[40:43], 0 offen
L_f1_done:
    s_mov_b64 exec, -1
    s_waitcnt lgkmcnt(0)
    s_barrier
    v_add_u32 v37, 73728, v39
    v_add_u32 v38, 73728, v40
    v_mfma_f32_16x16x32_bf16 v[56:59], v[144:147], v[124:127], v[56:59]
    ds_read_b128 v[116:119], v37 offset:0
    ds_read_b128 v[120:123], v37 offset:6144
    v_mfma_f32_16x16x32_bf16 v[60:63], v[148:151], v[124:127], v[60:63]
    ds_read_b64_tr_b16 v[96:97], v35 offset:20480
    ds_read_b64_tr_b16 v[98:99], v35 offset:21760
    v_mfma_f32_16x16x32_bf16 v[64:67], v[144:147], v[128:131], v[64:67]
    ds_read_b64_tr_b16 v[100:101], v36 offset:20512
    ds_read_b64_tr_b16 v[102:103], v36 offset:21792
    v_mfma_f32_16x16x32_bf16 v[68:71], v[148:151], v[128:131], v[68:71]
    ds_read_b64_tr_b16 v[104:105], v35 offset:20544
    v_mfma_f32_16x16x32_bf16 v[72:75], v[144:147], v[132:135], v[72:75]
    ds_read_b64_tr_b16 v[106:107], v35 offset:21824
    v_mfma_f32_16x16x32_bf16 v[76:79], v[148:151], v[132:135], v[76:79]
    ds_read_b64_tr_b16 v[108:109], v36 offset:20576
    v_mfma_f32_16x16x32_bf16 v[80:83], v[144:147], v[136:139], v[80:83]
    ds_read_b64_tr_b16 v[110:111], v36 offset:21856
    v_mfma_f32_16x16x32_bf16 v[84:87], v[148:151], v[136:139], v[84:87]
    ds_read_b64_tr_b16 v[112:113], v35 offset:20608
    v_mfma_f32_16x16x32_bf16 v[88:91], v[144:147], v[140:143], v[88:91]
    ds_read_b64_tr_b16 v[114:115], v35 offset:21888
    v_mfma_f32_16x16x32_bf16 v[92:95], v[148:151], v[140:143], v[92:95]
    s_nop 7
    v_cvt_pk_bf16_f32 v152, v56, v57
    v_cvt_pk_bf16_f32 v153, v58, v59
    v_cvt_pk_bf16_f32 v154, v60, v61
    v_cvt_pk_bf16_f32 v155, v62, v63
    v_cvt_pk_bf16_f32 v156, v64, v65
    v_cvt_pk_bf16_f32 v157, v66, v67
    v_cvt_pk_bf16_f32 v158, v68, v69
    v_cvt_pk_bf16_f32 v159, v70, v71
    v_cvt_pk_bf16_f32 v160, v72, v73
    v_cvt_pk_bf16_f32 v161, v74, v75
    v_cvt_pk_bf16_f32 v162, v76, v77
    v_cvt_pk_bf16_f32 v163, v78, v79
    v_cvt_pk_bf16_f32 v164, v80, v81
    v_cvt_pk_bf16_f32 v165, v82, v83
    v_cvt_pk_bf16_f32 v166, v84, v85
    v_cvt_pk_bf16_f32 v167, v86, v87
    v_cvt_pk_bf16_f32 v168, v88, v89
    v_cvt_pk_bf16_f32 v169, v90, v91
    v_cvt_pk_bf16_f32 v170, v92, v93
    v_cvt_pk_bf16_f32 v171, v94, v95
    s_waitcnt lgkmcnt(0)
    v_mfma_f32_16x16x32_bf16 v[56:59], v[116:119], v[96:99], 0
    ds_read_b128 v[144:147], v38 offset:0
    ds_read_b128 v[148:151], v38 offset:6144
    v_mfma_f32_16x16x32_bf16 v[60:63], v[120:123], v[96:99], 0
    ds_read_b64_tr_b16 v[124:125], v35 offset:30720
    ds_read_b64_tr_b16 v[126:127], v35 offset:32000
    v_mfma_f32_16x16x32_bf16 v[64:67], v[116:119], v[100:103], 0
    ds_read_b64_tr_b16 v[128:129], v36 offset:30752
    ds_read_b64_tr_b16 v[130:131], v36 offset:32032
    v_mfma_f32_16x16x32_bf16 v[68:71], v[120:123], v[100:103], 0
    ds_read_b64_tr_b16 v[132:133], v35 offset:30784
    v_mfma_f32_16x16x32_bf16 v[72:75], v[116:119], v[104:107], 0
    ds_read_b64_tr_b16 v[134:135], v35 offset:32064
    v_mfma_f32_16x16x32_bf16 v[76:79], v[120:123], v[104:107], 0
    ds_read_b64_tr_b16 v[136:137], v36 offset:30816
    v_mfma_f32_16x16x32_bf16 v[80:83], v[116:119], v[108:111], 0
    ds_read_b64_tr_b16 v[138:139], v36 offset:32096
    v_mfma_f32_16x16x32_bf16 v[84:87], v[120:123], v[108:111], 0
    ds_read_b64_tr_b16 v[140:141], v35 offset:30848
    v_mfma_f32_16x16x32_bf16 v[88:91], v[116:119], v[112:115], 0
    ds_read_b64_tr_b16 v[142:143], v35 offset:32128
    v_mfma_f32_16x16x32_bf16 v[92:95], v[120:123], v[112:115], 0
    s_waitcnt lgkmcnt(0)
    s_barrier
    v_mfma_f32_16x16x32_bf16 v[56:59], v[144:147], v[124:127], v[56:59]
    ds_read_b128 v[116:119], v37 offset:128
    ds_read_b128 v[120:123], v37 offset:6272
    v_mfma_f32_16x16x32_bf16 v[60:63], v[148:151], v[124:127], v[60:63]
    ds_read_b64_tr_b16 v[96:97], v35 offset:40960
    ds_read_b64_tr_b16 v[98:99], v35 offset:42240
    v_mfma_f32_16x16x32_bf16 v[64:67], v[144:147], v[128:131], v[64:67]
    ds_read_b64_tr_b16 v[100:101], v36 offset:40992
    ds_read_b64_tr_b16 v[102:103], v36 offset:42272
    v_mfma_f32_16x16x32_bf16 v[68:71], v[148:151], v[128:131], v[68:71]
    ds_read_b64_tr_b16 v[104:105], v35 offset:41024
    v_mfma_f32_16x16x32_bf16 v[72:75], v[144:147], v[132:135], v[72:75]
    ds_read_b64_tr_b16 v[106:107], v35 offset:42304
    v_mfma_f32_16x16x32_bf16 v[76:79], v[148:151], v[132:135], v[76:79]
    ds_read_b64_tr_b16 v[108:109], v36 offset:41056
    v_mfma_f32_16x16x32_bf16 v[80:83], v[144:147], v[136:139], v[80:83]
    ds_read_b64_tr_b16 v[110:111], v36 offset:42336
    v_mfma_f32_16x16x32_bf16 v[84:87], v[148:151], v[136:139], v[84:87]
    ds_read_b64_tr_b16 v[112:113], v35 offset:41088
    v_mfma_f32_16x16x32_bf16 v[88:91], v[144:147], v[140:143], v[88:91]
    ds_read_b64_tr_b16 v[114:115], v35 offset:42368
    v_mfma_f32_16x16x32_bf16 v[92:95], v[148:151], v[140:143], v[92:95]
    s_waitcnt lgkmcnt(0)
    v_mfma_f32_16x16x32_bf16 v[56:59], v[116:119], v[96:99], v[56:59]
    ds_read_b128 v[144:147], v38 offset:128
    ds_read_b128 v[148:151], v38 offset:6272
    v_mfma_f32_16x16x32_bf16 v[60:63], v[120:123], v[96:99], v[60:63]
    ds_read_b64_tr_b16 v[124:125], v35 offset:51200
    ds_read_b64_tr_b16 v[126:127], v35 offset:52480
    v_mfma_f32_16x16x32_bf16 v[64:67], v[116:119], v[100:103], v[64:67]
    ds_read_b64_tr_b16 v[128:129], v36 offset:51232
    ds_read_b64_tr_b16 v[130:131], v36 offset:52512
    v_mfma_f32_16x16x32_bf16 v[68:71], v[120:123], v[100:103], v[68:71]
    ds_read_b64_tr_b16 v[132:133], v35 offset:51264
    v_mfma_f32_16x16x32_bf16 v[72:75], v[116:119], v[104:107], v[72:75]
    ds_read_b64_tr_b16 v[134:135], v35 offset:52544
    v_mfma_f32_16x16x32_bf16 v[76:79], v[120:123], v[104:107], v[76:79]
    ds_read_b64_tr_b16 v[136:137], v36 offset:51296
    v_mfma_f32_16x16x32_bf16 v[80:83], v[116:119], v[108:111], v[80:83]
    ds_read_b64_tr_b16 v[138:139], v36 offset:52576
    v_mfma_f32_16x16x32_bf16 v[84:87], v[120:123], v[108:111], v[84:87]
    ds_read_b64_tr_b16 v[140:141], v35 offset:51328
    v_mfma_f32_16x16x32_bf16 v[88:91], v[116:119], v[112:115], v[88:91]
    ds_read_b64_tr_b16 v[142:143], v35 offset:52608
    v_mfma_f32_16x16x32_bf16 v[92:95], v[120:123], v[112:115], v[92:95]
    s_waitcnt lgkmcnt(0)
    s_barrier
    v_mfma_f32_16x16x32_bf16 v[56:59], v[144:147], v[124:127], v[56:59]
    ds_read_b128 v[116:119], v37 offset:256
    ds_read_b128 v[120:123], v37 offset:6400
    v_mfma_f32_16x16x32_bf16 v[60:63], v[148:151], v[124:127], v[60:63]
    ds_read_b64_tr_b16 v[96:97], v35 offset:0
    ds_read_b64_tr_b16 v[98:99], v35 offset:1280
    v_mfma_f32_16x16x32_bf16 v[64:67], v[144:147], v[128:131], v[64:67]
    ds_read_b64_tr_b16 v[100:101], v36 offset:32
    ds_read_b64_tr_b16 v[102:103], v36 offset:1312
    v_mfma_f32_16x16x32_bf16 v[68:71], v[148:151], v[128:131], v[68:71]
    ds_read_b64_tr_b16 v[104:105], v35 offset:64
    v_mfma_f32_16x16x32_bf16 v[72:75], v[144:147], v[132:135], v[72:75]
    ds_read_b64_tr_b16 v[106:107], v35 offset:1344
    v_mfma_f32_16x16x32_bf16 v[76:79], v[148:151], v[132:135], v[76:79]
    ds_read_b64_tr_b16 v[108:109], v36 offset:96
    v_mfma_f32_16x16x32_bf16 v[80:83], v[144:147], v[136:139], v[80:83]
    ds_read_b64_tr_b16 v[110:111], v36 offset:1376
    v_mfma_f32_16x16x32_bf16 v[84:87], v[148:151], v[136:139], v[84:87]
    ds_read_b64_tr_b16 v[112:113], v35 offset:128
    v_mfma_f32_16x16x32_bf16 v[88:91], v[144:147], v[140:143], v[88:91]
    ds_read_b64_tr_b16 v[114:115], v35 offset:1408
    v_mfma_f32_16x16x32_bf16 v[92:95], v[148:151], v[140:143], v[92:95]
    s_waitcnt lgkmcnt(0)
    v_mfma_f32_16x16x32_bf16 v[56:59], v[116:119], v[96:99], v[56:59]
    ds_read_b128 v[144:147], v38 offset:256
    ds_read_b128 v[148:151], v38 offset:6400
    v_mfma_f32_16x16x32_bf16 v[60:63], v[120:123], v[96:99], v[60:63]
    ds_read_b64_tr_b16 v[124:125], v35 offset:10240
    ds_read_b64_tr_b16 v[126:127], v35 offset:11520
    v_mfma_f32_16x16x32_bf16 v[64:67], v[116:119], v[100:103], v[64:67]
    ds_read_b64_tr_b16 v[128:129], v36 offset:10272
    ds_read_b64_tr_b16 v[130:131], v36 offset:11552
    v_mfma_f32_16x16x32_bf16 v[68:71], v[120:123], v[100:103], v[68:71]
    ds_read_b64_tr_b16 v[132:133], v35 offset:10304
    v_mfma_f32_16x16x32_bf16 v[72:75], v[116:119], v[104:107], v[72:75]
    ds_read_b64_tr_b16 v[134:135], v35 offset:11584
    v_mfma_f32_16x16x32_bf16 v[76:79], v[120:123], v[104:107], v[76:79]
    ds_read_b64_tr_b16 v[136:137], v36 offset:10336
    v_mfma_f32_16x16x32_bf16 v[80:83], v[116:119], v[108:111], v[80:83]
    ds_read_b64_tr_b16 v[138:139], v36 offset:11616
    v_mfma_f32_16x16x32_bf16 v[84:87], v[120:123], v[108:111], v[84:87]
    ds_read_b64_tr_b16 v[140:141], v35 offset:10368
    v_mfma_f32_16x16x32_bf16 v[88:91], v[116:119], v[112:115], v[88:91]
    ds_read_b64_tr_b16 v[142:143], v35 offset:11648
    v_mfma_f32_16x16x32_bf16 v[92:95], v[120:123], v[112:115], v[92:95]
    s_waitcnt lgkmcnt(0)
    s_barrier
    v_add_u32 v37, 0, v39
    v_add_u32 v38, 0, v40
    v_mfma_f32_16x16x32_bf16 v[56:59], v[144:147], v[124:127], v[56:59]
    ds_read_b128 v[116:119], v37 offset:0
    ds_read_b128 v[120:123], v37 offset:6144
    v_mfma_f32_16x16x32_bf16 v[60:63], v[148:151], v[124:127], v[60:63]
    ds_read_b64_tr_b16 v[96:97], v35 offset:20480
    ds_read_b64_tr_b16 v[98:99], v35 offset:21760
    v_mfma_f32_16x16x32_bf16 v[64:67], v[144:147], v[128:131], v[64:67]
    ds_read_b64_tr_b16 v[100:101], v36 offset:20512
    ds_read_b64_tr_b16 v[102:103], v36 offset:21792
    v_mfma_f32_16x16x32_bf16 v[68:71], v[148:151], v[128:131], v[68:71]
    ds_read_b64_tr_b16 v[104:105], v35 offset:20544
    v_mfma_f32_16x16x32_bf16 v[72:75], v[144:147], v[132:135], v[72:75]
    ds_read_b64_tr_b16 v[106:107], v35 offset:21824
    v_mfma_f32_16x16x32_bf16 v[76:79], v[148:151], v[132:135], v[76:79]
    ds_read_b64_tr_b16 v[108:109], v36 offset:20576
    v_mfma_f32_16x16x32_bf16 v[80:83], v[144:147], v[136:139], v[80:83]
    ds_read_b64_tr_b16 v[110:111], v36 offset:21856
    v_mfma_f32_16x16x32_bf16 v[84:87], v[148:151], v[136:139], v[84:87]
    ds_read_b64_tr_b16 v[112:113], v35 offset:20608
    v_mfma_f32_16x16x32_bf16 v[88:91], v[144:147], v[140:143], v[88:91]
    ds_read_b64_tr_b16 v[114:115], v35 offset:21888
    v_mfma_f32_16x16x32_bf16 v[92:95], v[148:151], v[140:143], v[92:95]
    s_nop 7
    v_cvt_pk_bf16_f32 v172, v56, v57
    v_cvt_pk_bf16_f32 v173, v58, v59
    v_cvt_pk_bf16_f32 v174, v60, v61
    v_cvt_pk_bf16_f32 v175, v62, v63
    v_cvt_pk_bf16_f32 v176, v64, v65
    v_cvt_pk_bf16_f32 v177, v66, v67
    v_cvt_pk_bf16_f32 v178, v68, v69
    v_cvt_pk_bf16_f32 v179, v70, v71
    v_cvt_pk_bf16_f32 v180, v72, v73
    v_cvt_pk_bf16_f32 v181, v74, v75
    v_cvt_pk_bf16_f32 v182, v76, v77
    v_cvt_pk_bf16_f32 v183, v78, v79
    v_cvt_pk_bf16_f32 v184, v80, v81
    v_cvt_pk_bf16_f32 v185, v82, v83
    v_cvt_pk_bf16_f32 v186, v84, v85
    v_cvt_pk_bf16_f32 v187, v86, v87
    v_cvt_pk_bf16_f32 v188, v88, v89
    v_cvt_pk_bf16_f32 v189, v90, v91
    v_cvt_pk_bf16_f32 v190, v92, v93
    v_cvt_pk_bf16_f32 v191, v94, v95
    s_waitcnt lgkmcnt(0)
    v_mfma_f32_16x16x32_bf16 v[56:59], v[116:119], v[96:99], 0
    ds_read_b128 v[144:147], v38 offset:0
    ds_read_b128 v[148:151], v38 offset:6144
    v_mfma_f32_16x16x32_bf16 v[60:63], v[120:123], v[96:99], 0
    ds_read_b64_tr_b16 v[124:125], v35 offset:30720
    ds_read_b64_tr_b16 v[126:127], v35 offset:32000
    v_mfma_f32_16x16x32_bf16 v[64:67], v[116:119], v[100:103], 0
    ds_read_b64_tr_b16 v[128:129], v36 offset:30752
    ds_read_b64_tr_b16 v[130:131], v36 offset:32032
    v_mfma_f32_16x16x32_bf16 v[68:71], v[120:123], v[100:103], 0
    ds_read_b64_tr_b16 v[132:133], v35 offset:30784
    v_mfma_f32_16x16x32_bf16 v[72:75], v[116:119], v[104:107], 0
    ds_read_b64_tr_b16 v[134:135], v35 offset:32064
    v_mfma_f32_16x16x32_bf16 v[76:79], v[120:123], v[104:107], 0
    ds_read_b64_tr_b16 v[136:137], v36 offset:30816
    v_mfma_f32_16x16x32_bf16 v[80:83], v[116:119], v[108:111], 0
    ds_read_b64_tr_b16 v[138:139], v36 offset:32096
    v_mfma_f32_16x16x32_bf16 v[84:87], v[120:123], v[108:111], 0
    ds_read_b64_tr_b16 v[140:141], v35 offset:30848
    v_mfma_f32_16x16x32_bf16 v[88:91], v[116:119], v[112:115], 0
    ds_read_b64_tr_b16 v[142:143], v35 offset:32128
    v_mfma_f32_16x16x32_bf16 v[92:95], v[120:123], v[112:115], 0
    s_waitcnt lgkmcnt(0)
    s_barrier
    v_mfma_f32_16x16x32_bf16 v[56:59], v[144:147], v[124:127], v[56:59]
    ds_read_b128 v[116:119], v37 offset:128
    ds_read_b128 v[120:123], v37 offset:6272
    v_mfma_f32_16x16x32_bf16 v[60:63], v[148:151], v[124:127], v[60:63]
    ds_read_b64_tr_b16 v[96:97], v35 offset:40960
    ds_read_b64_tr_b16 v[98:99], v35 offset:42240
    v_mfma_f32_16x16x32_bf16 v[64:67], v[144:147], v[128:131], v[64:67]
    ds_read_b64_tr_b16 v[100:101], v36 offset:40992
    ds_read_b64_tr_b16 v[102:103], v36 offset:42272
    v_mfma_f32_16x16x32_bf16 v[68:71], v[148:151], v[128:131], v[68:71]
    ds_read_b64_tr_b16 v[104:105], v35 offset:41024
    v_mfma_f32_16x16x32_bf16 v[72:75], v[144:147], v[132:135], v[72:75]
    ds_read_b64_tr_b16 v[106:107], v35 offset:42304
    v_mfma_f32_16x16x32_bf16 v[76:79], v[148:151], v[132:135], v[76:79]
    ds_read_b64_tr_b16 v[108:109], v36 offset:41056
    v_mfma_f32_16x16x32_bf16 v[80:83], v[144:147], v[136:139], v[80:83]
    ds_read_b64_tr_b16 v[110:111], v36 offset:42336
    v_mfma_f32_16x16x32_bf16 v[84:87], v[148:151], v[136:139], v[84:87]
    ds_read_b64_tr_b16 v[112:113], v35 offset:41088
    v_mfma_f32_16x16x32_bf16 v[88:91], v[144:147], v[140:143], v[88:91]
    ds_read_b64_tr_b16 v[114:115], v35 offset:42368
    v_mfma_f32_16x16x32_bf16 v[92:95], v[148:151], v[140:143], v[92:95]
    s_waitcnt lgkmcnt(0)
    v_mfma_f32_16x16x32_bf16 v[56:59], v[116:119], v[96:99], v[56:59]
    ds_read_b128 v[144:147], v38 offset:128
    ds_read_b128 v[148:151], v38 offset:6272
    v_mfma_f32_16x16x32_bf16 v[60:63], v[120:123], v[96:99], v[60:63]
    ds_read_b64_tr_b16 v[124:125], v35 offset:51200
    ds_read_b64_tr_b16 v[126:127], v35 offset:52480
    v_mfma_f32_16x16x32_bf16 v[64:67], v[116:119], v[100:103], v[64:67]
    ds_read_b64_tr_b16 v[128:129], v36 offset:51232
    ds_read_b64_tr_b16 v[130:131], v36 offset:52512
    v_mfma_f32_16x16x32_bf16 v[68:71], v[120:123], v[100:103], v[68:71]
    ds_read_b64_tr_b16 v[132:133], v35 offset:51264
    v_mfma_f32_16x16x32_bf16 v[72:75], v[116:119], v[104:107], v[72:75]
    ds_read_b64_tr_b16 v[134:135], v35 offset:52544
    v_mfma_f32_16x16x32_bf16 v[76:79], v[120:123], v[104:107], v[76:79]
    ds_read_b64_tr_b16 v[136:137], v36 offset:51296
    v_mfma_f32_16x16x32_bf16 v[80:83], v[116:119], v[108:111], v[80:83]
    ds_read_b64_tr_b16 v[138:139], v36 offset:52576
    v_mfma_f32_16x16x32_bf16 v[84:87], v[120:123], v[108:111], v[84:87]
    ds_read_b64_tr_b16 v[140:141], v35 offset:51328
    v_mfma_f32_16x16x32_bf16 v[88:91], v[116:119], v[112:115], v[88:91]
    ds_read_b64_tr_b16 v[142:143], v35 offset:52608
    v_mfma_f32_16x16x32_bf16 v[92:95], v[120:123], v[112:115], v[92:95]
    s_waitcnt lgkmcnt(0)
    s_barrier
    v_mfma_f32_16x16x32_bf16 v[56:59], v[144:147], v[124:127], v[56:59]
    ds_read_b128 v[116:119], v37 offset:256
    ds_read_b128 v[120:123], v37 offset:6400
    v_mfma_f32_16x16x32_bf16 v[60:63], v[148:151], v[124:127], v[60:63]
    ds_read_b64_tr_b16 v[96:97], v35 offset:0
    ds_read_b64_tr_b16 v[98:99], v35 offset:1280
    v_mfma_f32_16x16x32_bf16 v[64:67], v[144:147], v[128:131], v[64:67]
    ds_read_b64_tr_b16 v[100:101], v36 offset:32
    ds_read_b64_tr_b16 v[102:103], v36 offset:1312
    v_mfma_f32_16x16x32_bf16 v[68:71], v[148:151], v[128:131], v[68:71]
    ds_read_b64_tr_b16 v[104:105], v35 offset:64
    v_mfma_f32_16x16x32_bf16 v[72:75], v[144:147], v[132:135], v[72:75]
    ds_read_b64_tr_b16 v[106:107], v35 offset:1344
    v_mfma_f32_16x16x32_bf16 v[76:79], v[148:151], v[132:135], v[76:79]
    ds_read_b64_tr_b16 v[108:109], v36 offset:96
    v_mfma_f32_16x16x32_bf16 v[80:83], v[144:147], v[136:139], v[80:83]
    ds_read_b64_tr_b16 v[110:111], v36 offset:1376
    v_mfma_f32_16x16x32_bf16 v[84:87], v[148:151], v[136:139], v[84:87]
    ds_read_b64_tr_b16 v[112:113], v35 offset:128
    v_mfma_f32_16x16x32_bf16 v[88:91], v[144:147], v[140:143], v[88:91]
    ds_read_b64_tr_b16 v[114:115], v35 offset:1408
    v_mfma_f32_16x16x32_bf16 v[92:95], v[148:151], v[140:143], v[92:95]
    s_waitcnt lgkmcnt(0)
    v_mfma_f32_16x16x32_bf16 v[56:59], v[116:119], v[96:99], v[56:59]
    ds_read_b128 v[144:147], v38 offset:256
    ds_read_b128 v[148:151], v38 offset:6400
    v_mfma_f32_16x16x32_bf16 v[60:63], v[120:123], v[96:99], v[60:63]
    ds_read_b64_tr_b16 v[124:125], v35 offset:10240
    ds_read_b64_tr_b16 v[126:127], v35 offset:11520
    v_mfma_f32_16x16x32_bf16 v[64:67], v[116:119], v[100:103], v[64:67]
    ds_read_b64_tr_b16 v[128:129], v36 offset:10272
    ds_read_b64_tr_b16 v[130:131], v36 offset:11552
    v_mfma_f32_16x16x32_bf16 v[68:71], v[120:123], v[100:103], v[68:71]
    ds_read_b64_tr_b16 v[132:133], v35 offset:10304
    v_mfma_f32_16x16x32_bf16 v[72:75], v[116:119], v[104:107], v[72:75]
    ds_read_b64_tr_b16 v[134:135], v35 offset:11584
    v_mfma_f32_16x16x32_bf16 v[76:79], v[120:123], v[104:107], v[76:79]
    ds_read_b64_tr_b16 v[136:137], v36 offset:10336
    v_mfma_f32_16x16x32_bf16 v[80:83], v[116:119], v[108:111], v[80:83]
    ds_read_b64_tr_b16 v[138:139], v36 offset:11616
    v_mfma_f32_16x16x32_bf16 v[84:87], v[120:123], v[108:111], v[84:87]
    ds_read_b64_tr_b16 v[140:141], v35 offset:10368
    v_mfma_f32_16x16x32_bf16 v[88:91], v[116:119], v[112:115], v[88:91]
    ds_read_b64_tr_b16 v[142:143], v35 offset:11648
    v_mfma_f32_16x16x32_bf16 v[92:95], v[120:123], v[112:115], v[92:95]
    s_waitcnt lgkmcnt(0)
    s_barrier
    v_add_u32 v37, 49152, v39
    v_add_u32 v38, 49152, v40
    v_mfma_f32_16x16x32_bf16 v[56:59], v[144:147], v[124:127], v[56:59]
    ds_read_b128 v[116:119], v37 offset:0
    ds_read_b128 v[120:123], v37 offset:6144
    v_mfma_f32_16x16x32_bf16 v[60:63], v[148:151], v[124:127], v[60:63]
    ds_read_b64_tr_b16 v[96:97], v35 offset:20480
    ds_read_b64_tr_b16 v[98:99], v35 offset:21760
    v_mfma_f32_16x16x32_bf16 v[64:67], v[144:147], v[128:131], v[64:67]
    ds_read_b64_tr_b16 v[100:101], v36 offset:20512
    ds_read_b64_tr_b16 v[102:103], v36 offset:21792
    v_mfma_f32_16x16x32_bf16 v[68:71], v[148:151], v[128:131], v[68:71]
    ds_read_b64_tr_b16 v[104:105], v35 offset:20544
    v_mfma_f32_16x16x32_bf16 v[72:75], v[144:147], v[132:135], v[72:75]
    ds_read_b64_tr_b16 v[106:107], v35 offset:21824
    v_mfma_f32_16x16x32_bf16 v[76:79], v[148:151], v[132:135], v[76:79]
    ds_read_b64_tr_b16 v[108:109], v36 offset:20576
    v_mfma_f32_16x16x32_bf16 v[80:83], v[144:147], v[136:139], v[80:83]
    ds_read_b64_tr_b16 v[110:111], v36 offset:21856
    v_mfma_f32_16x16x32_bf16 v[84:87], v[148:151], v[136:139], v[84:87]
    ds_read_b64_tr_b16 v[112:113], v35 offset:20608
    v_mfma_f32_16x16x32_bf16 v[88:91], v[144:147], v[140:143], v[88:91]
    ds_read_b64_tr_b16 v[114:115], v35 offset:21888
    v_mfma_f32_16x16x32_bf16 v[92:95], v[148:151], v[140:143], v[92:95]
    s_nop 7
    v_cvt_pk_bf16_f32 v192, v56, v57
    v_cvt_pk_bf16_f32 v193, v58, v59
    v_cvt_pk_bf16_f32 v194, v60, v61
    v_cvt_pk_bf16_f32 v195, v62, v63
    v_cvt_pk_bf16_f32 v196, v64, v65
    v_cvt_pk_bf16_f32 v197, v66, v67
    v_cvt_pk_bf16_f32 v198, v68, v69
    v_cvt_pk_bf16_f32 v199, v70, v71
    v_cvt_pk_bf16_f32 v200, v72, v73
    v_cvt_pk_bf16_f32 v201, v74, v75
    v_cvt_pk_bf16_f32 v202, v76, v77
    v_cvt_pk_bf16_f32 v203, v78, v79
    v_cvt_pk_bf16_f32 v204, v80, v81
    v_cvt_pk_bf16_f32 v205, v82, v83
    v_cvt_pk_bf16_f32 v206, v84, v85
    v_cvt_pk_bf16_f32 v207, v86, v87
    v_cvt_pk_bf16_f32 v208, v88, v89
    v_cvt_pk_bf16_f32 v209, v90, v91
    v_cvt_pk_bf16_f32 v210, v92, v93
    v_cvt_pk_bf16_f32 v211, v94, v95
    s_waitcnt lgkmcnt(0)
    v_mfma_f32_16x16x32_bf16 v[56:59], v[116:119], v[96:99], 0
    ds_read_b128 v[144:147], v38 offset:0
    ds_read_b128 v[148:151], v38 offset:6144
    v_mfma_f32_16x16x32_bf16 v[60:63], v[120:123], v[96:99], 0
    ds_read_b64_tr_b16 v[124:125], v35 offset:30720
    ds_read_b64_tr_b16 v[126:127], v35 offset:32000
    v_mfma_f32_16x16x32_bf16 v[64:67], v[116:119], v[100:103], 0
    ds_read_b64_tr_b16 v[128:129], v36 offset:30752
    ds_read_b64_tr_b16 v[130:131], v36 offset:32032
    v_mfma_f32_16x16x32_bf16 v[68:71], v[120:123], v[100:103], 0
    ds_read_b64_tr_b16 v[132:133], v35 offset:30784
    v_mfma_f32_16x16x32_bf16 v[72:75], v[116:119], v[104:107], 0
    ds_read_b64_tr_b16 v[134:135], v35 offset:32064
    v_mfma_f32_16x16x32_bf16 v[76:79], v[120:123], v[104:107], 0
    ds_read_b64_tr_b16 v[136:137], v36 offset:30816
    v_mfma_f32_16x16x32_bf16 v[80:83], v[116:119], v[108:111], 0
    ds_read_b64_tr_b16 v[138:139], v36 offset:32096
    v_mfma_f32_16x16x32_bf16 v[84:87], v[120:123], v[108:111], 0
    ds_read_b64_tr_b16 v[140:141], v35 offset:30848
    v_mfma_f32_16x16x32_bf16 v[88:91], v[116:119], v[112:115], 0
    ds_read_b64_tr_b16 v[142:143], v35 offset:32128
    v_mfma_f32_16x16x32_bf16 v[92:95], v[120:123], v[112:115], 0
    s_waitcnt lgkmcnt(0)
    s_barrier
    v_mfma_f32_16x16x32_bf16 v[56:59], v[144:147], v[124:127], v[56:59]
    ds_read_b128 v[116:119], v37 offset:128
    ds_read_b128 v[120:123], v37 offset:6272
    v_mfma_f32_16x16x32_bf16 v[60:63], v[148:151], v[124:127], v[60:63]
    ds_read_b64_tr_b16 v[96:97], v35 offset:40960
    ds_read_b64_tr_b16 v[98:99], v35 offset:42240
    v_mfma_f32_16x16x32_bf16 v[64:67], v[144:147], v[128:131], v[64:67]
    ds_read_b64_tr_b16 v[100:101], v36 offset:40992
    ds_read_b64_tr_b16 v[102:103], v36 offset:42272
    v_mfma_f32_16x16x32_bf16 v[68:71], v[148:151], v[128:131], v[68:71]
    ds_read_b64_tr_b16 v[104:105], v35 offset:41024
    v_mfma_f32_16x16x32_bf16 v[72:75], v[144:147], v[132:135], v[72:75]
    ds_read_b64_tr_b16 v[106:107], v35 offset:42304
    v_mfma_f32_16x16x32_bf16 v[76:79], v[148:151], v[132:135], v[76:79]
    ds_read_b64_tr_b16 v[108:109], v36 offset:41056
    v_mfma_f32_16x16x32_bf16 v[80:83], v[144:147], v[136:139], v[80:83]
    ds_read_b64_tr_b16 v[110:111], v36 offset:42336
    v_mfma_f32_16x16x32_bf16 v[84:87], v[148:151], v[136:139], v[84:87]
    ds_read_b64_tr_b16 v[112:113], v35 offset:41088
    v_mfma_f32_16x16x32_bf16 v[88:91], v[144:147], v[140:143], v[88:91]
    ds_read_b64_tr_b16 v[114:115], v35 offset:42368
    v_mfma_f32_16x16x32_bf16 v[92:95], v[148:151], v[140:143], v[92:95]
    s_waitcnt lgkmcnt(0)
    v_mfma_f32_16x16x32_bf16 v[56:59], v[116:119], v[96:99], v[56:59]
    ds_read_b128 v[144:147], v38 offset:128
    ds_read_b128 v[148:151], v38 offset:6272
    v_mfma_f32_16x16x32_bf16 v[60:63], v[120:123], v[96:99], v[60:63]
    ds_read_b64_tr_b16 v[124:125], v35 offset:51200
    ds_read_b64_tr_b16 v[126:127], v35 offset:52480
    v_mfma_f32_16x16x32_bf16 v[64:67], v[116:119], v[100:103], v[64:67]
    ds_read_b64_tr_b16 v[128:129], v36 offset:51232
    ds_read_b64_tr_b16 v[130:131], v36 offset:52512
    v_mfma_f32_16x16x32_bf16 v[68:71], v[120:123], v[100:103], v[68:71]
    ds_read_b64_tr_b16 v[132:133], v35 offset:51264
    v_mfma_f32_16x16x32_bf16 v[72:75], v[116:119], v[104:107], v[72:75]
    ds_read_b64_tr_b16 v[134:135], v35 offset:52544
    v_mfma_f32_16x16x32_bf16 v[76:79], v[120:123], v[104:107], v[76:79]
    ds_read_b64_tr_b16 v[136:137], v36 offset:51296
    v_mfma_f32_16x16x32_bf16 v[80:83], v[116:119], v[108:111], v[80:83]
    ds_read_b64_tr_b16 v[138:139], v36 offset:52576
    v_mfma_f32_16x16x32_bf16 v[84:87], v[120:123], v[108:111], v[84:87]
    ds_read_b64_tr_b16 v[140:141], v35 offset:51328
    v_mfma_f32_16x16x32_bf16 v[88:91], v[116:119], v[112:115], v[88:91]
    ds_read_b64_tr_b16 v[142:143], v35 offset:52608
    v_mfma_f32_16x16x32_bf16 v[92:95], v[120:123], v[112:115], v[92:95]
    s_waitcnt lgkmcnt(0)
    s_barrier
    v_mfma_f32_16x16x32_bf16 v[56:59], v[144:147], v[124:127], v[56:59]
    ds_read_b128 v[116:119], v37 offset:256
    ds_read_b128 v[120:123], v37 offset:6400
    v_mfma_f32_16x16x32_bf16 v[60:63], v[148:151], v[124:127], v[60:63]
    ds_read_b64_tr_b16 v[96:97], v35 offset:0
    ds_read_b64_tr_b16 v[98:99], v35 offset:1280
    v_mfma_f32_16x16x32_bf16 v[64:67], v[144:147], v[128:131], v[64:67]
    ds_read_b64_tr_b16 v[100:101], v36 offset:32
    ds_read_b64_tr_b16 v[102:103], v36 offset:1312
    v_mfma_f32_16x16x32_bf16 v[68:71], v[148:151], v[128:131], v[68:71]
    ds_read_b64_tr_b16 v[104:105], v35 offset:64
    v_mfma_f32_16x16x32_bf16 v[72:75], v[144:147], v[132:135], v[72:75]
    ds_read_b64_tr_b16 v[106:107], v35 offset:1344
    v_mfma_f32_16x16x32_bf16 v[76:79], v[148:151], v[132:135], v[76:79]
    ds_read_b64_tr_b16 v[108:109], v36 offset:96
    v_mfma_f32_16x16x32_bf16 v[80:83], v[144:147], v[136:139], v[80:83]
    ds_read_b64_tr_b16 v[110:111], v36 offset:1376
    v_mfma_f32_16x16x32_bf16 v[84:87], v[148:151], v[136:139], v[84:87]
    ds_read_b64_tr_b16 v[112:113], v35 offset:128
    v_mfma_f32_16x16x32_bf16 v[88:91], v[144:147], v[140:143], v[88:91]
    ds_read_b64_tr_b16 v[114:115], v35 offset:1408
    v_mfma_f32_16x16x32_bf16 v[92:95], v[148:151], v[140:143], v[92:95]
    s_waitcnt lgkmcnt(0)
    v_mfma_f32_16x16x32_bf16 v[56:59], v[116:119], v[96:99], v[56:59]
    ds_read_b128 v[144:147], v38 offset:256
    ds_read_b128 v[148:151], v38 offset:6400
    v_mfma_f32_16x16x32_bf16 v[60:63], v[120:123], v[96:99], v[60:63]
    ds_read_b64_tr_b16 v[124:125], v35 offset:10240
    ds_read_b64_tr_b16 v[126:127], v35 offset:11520
    v_mfma_f32_16x16x32_bf16 v[64:67], v[116:119], v[100:103], v[64:67]
    ds_read_b64_tr_b16 v[128:129], v36 offset:10272
    ds_read_b64_tr_b16 v[130:131], v36 offset:11552
    v_mfma_f32_16x16x32_bf16 v[68:71], v[120:123], v[100:103], v[68:71]
    ds_read_b64_tr_b16 v[132:133], v35 offset:10304
    v_mfma_f32_16x16x32_bf16 v[72:75], v[116:119], v[104:107], v[72:75]
    ds_read_b64_tr_b16 v[134:135], v35 offset:11584
    v_mfma_f32_16x16x32_bf16 v[76:79], v[120:123], v[104:107], v[76:79]
    ds_read_b64_tr_b16 v[136:137], v36 offset:10336
    v_mfma_f32_16x16x32_bf16 v[80:83], v[116:119], v[108:111], v[80:83]
    ds_read_b64_tr_b16 v[138:139], v36 offset:11616
    v_mfma_f32_16x16x32_bf16 v[84:87], v[120:123], v[108:111], v[84:87]
    ds_read_b64_tr_b16 v[140:141], v35 offset:10368
    v_mfma_f32_16x16x32_bf16 v[88:91], v[116:119], v[112:115], v[88:91]
    ds_read_b64_tr_b16 v[142:143], v35 offset:11648
    v_mfma_f32_16x16x32_bf16 v[92:95], v[120:123], v[112:115], v[92:95]
    s_waitcnt lgkmcnt(0)
    v_mfma_f32_16x16x32_bf16 v[56:59], v[144:147], v[124:127], v[56:59]
    v_mfma_f32_16x16x32_bf16 v[60:63], v[148:151], v[124:127], v[60:63]
    v_mfma_f32_16x16x32_bf16 v[64:67], v[144:147], v[128:131], v[64:67]
    v_mfma_f32_16x16x32_bf16 v[68:71], v[148:151], v[128:131], v[68:71]
    v_mfma_f32_16x16x32_bf16 v[72:75], v[144:147], v[132:135], v[72:75]
    v_mfma_f32_16x16x32_bf16 v[76:79], v[148:151], v[132:135], v[76:79]
    v_mfma_f32_16x16x32_bf16 v[80:83], v[144:147], v[136:139], v[80:83]
    v_mfma_f32_16x16x32_bf16 v[84:87], v[148:151], v[136:139], v[84:87]
    v_mfma_f32_16x16x32_bf16 v[88:91], v[144:147], v[140:143], v[88:91]
    v_mfma_f32_16x16x32_bf16 v[92:95], v[148:151], v[140:143], v[92:95]
    s_and_b32 s8, s3, 1
    s_lshl_b32 s8, s8, 10
    v_lshlrev_b32 v7, 4, v2
    v_add_u32 v7, s8, v7
    s_nop 5
    v_cvt_pk_bf16_f32 v212, v56, v57
    v_cvt_pk_bf16_f32 v213, v58, v59
    v_cvt_pk_bf16_f32 v214, v60, v61
    v_cvt_pk_bf16_f32 v215, v62, v63
    v_cvt_pk_bf16_f32 v216, v64, v65
    v_cvt_pk_bf16_f32 v217, v66, v67
    v_cvt_pk_bf16_f32 v218, v68, v69
    v_cvt_pk_bf16_f32 v219, v70, v71
    v_cvt_pk_bf16_f32 v220, v72, v73
    v_cvt_pk_bf16_f32 v221, v74, v75
    v_cvt_pk_bf16_f32 v222, v76, v77
    v_cvt_pk_bf16_f32 v223, v78, v79
    v_cvt_pk_bf16_f32 v224, v80, v81
    v_cvt_pk_bf16_f32 v225, v82, v83
    v_cvt_pk_bf16_f32 v226, v84, v85
    v_cvt_pk_bf16_f32 v227, v86, v87
    v_cvt_pk_bf16_f32 v228, v88, v89
    v_cvt_pk_bf16_f32 v229, v90, v91
    v_cvt_pk_bf16_f32 v230, v92, v93
    v_cvt_pk_bf16_f32 v231, v94, v95
    s_barrier
    v_add_u32 v8, 0x10000, v7
    v_lshlrev_b32 v46, 4, v2
    s_mul_i32 s8, s3, 10240
    s_add_u32 s8, s8, 98304
    v_add_u32 v9, s8, v46
    s_xor_b32 s9, s3, 1
    s_mul_i32 s9, s9, 10240
    s_add_u32 s9, s9, 98304
    v_add_u32 v1, s9, v46
    ds_read_b128 v[232:235], v7 offset:24576
    ds_read_b128 v[236:239], v7 offset:26624
    ds_read_b128 v[240:243], v7 offset:28672
    ds_read_b128 v[244:247], v7 offset:30720
    ds_read_b128 v[16:19], v7 offset:32768
    ds_read_b128 v[20:23], v7 offset:34816
    ds_read_b128 v[24:27], v7 offset:36864
    ds_read_b128 v[28:31], v7 offset:38912
    s_waitcnt lgkmcnt(4)
    v_mfma_f32_16x16x32_bf16 v[56:59], v[152:155], v[232:235], 0
    v_mfma_f32_16x16x32_bf16 v[72:75], v[156:159], v[232:235], 0
    v_mfma_f32_16x16x32_bf16 v[88:91], v[160:163], v[232:235], 0
    v_mfma_f32_16x16x32_bf16 v[104:107], v[164:167], v[232:235], 0
    v_mfma_f32_16x16x32_bf16 v[120:123], v[168:171], v[232:235], 0
    v_mfma_f32_16x16x32_bf16 v[60:63], v[152:155], v[236:239], 0
    v_mfma_f32_16x16x32_bf16 v[76:79], v[156:159], v[236:239], 0
    v_mfma_f32_16x16x32_bf16 v[92:95], v[160:163], v[236:239], 0
    v_mfma_f32_16x16x32_bf16 v[108:111], v[164:167], v[236:239], 0
    v_mfma_f32_16x16x32_bf16 v[124:127], v[168:171], v[236:239], 0
    v_mfma_f32_16x16x32_bf16 v[64:67], v[152:155], v[240:243], 0
    v_mfma_f32_16x16x32_bf16 v[80:83], v[156:159], v[240:243], 0
    v_mfma_f32_16x16x32_bf16 v[96:99], v[160:163], v[240:243], 0
    v_mfma_f32_16x16x32_bf16 v[112:115], v[164:167], v[240:243], 0
    v_mfma_f32_16x16x32_bf16 v[128:131], v[168:171], v[240:243], 0
    v_mfma_f32_16x16x32_bf16 v[68:71], v[152:155], v[244:247], 0
    v_mfma_f32_16x16x32_bf16 v[84:87], v[156:159], v[244:247], 0
    v_mfma_f32_16x16x32_bf16 v[100:103], v[160:163], v[244:247], 0
    v_mfma_f32_16x16x32_bf16 v[116:119], v[164:167], v[244:247], 0
    v_mfma_f32_16x16x32_bf16 v[132:135], v[168:171], v[244:247], 0
    ds_read_b128 v[232:235], v7 offset:40960
    ds_read_b128 v[236:239], v7 offset:43008
    ds_read_b128 v[240:243], v7 offset:45056
    ds_read_b128 v[244:247], v7 offset:47104
    s_waitcnt lgkmcnt(4)
    v_mfma_f32_16x16x32_bf16 v[56:59], v[172:175], v[16:19], v[56:59]
    v_mfma_f32_16x16x32_bf16 v[72:75], v[176:179], v[16:19], v[72:75]
    v_mfma_f32_16x16x32_bf16 v[88:91], v[180:183], v[16:19], v[88:91]
    v_mfma_f32_16x16x32_bf16 v[104:107], v[184:187], v[16:19], v[104:107]
    v_mfma_f32_16x16x32_bf16 v[120:123], v[188:191], v[16:19], v[120:123]
    v_mfma_f32_16x16x32_bf16 v[60:63], v[172:175], v[20:23], v[60:63]
    v_mfma_f32_16x16x32_bf16 v[76:79], v[176:179], v[20:23], v[76:79]
    v_mfma_f32_16x16x32_bf16 v[92:95], v[180:183], v[20:23], v[92:95]
    v_mfma_f32_16x16x32_bf16 v[108:111], v[184:187], v[20:23], v[108:111]
    v_mfma_f32_16x16x32_bf16 v[124:127], v[188:191], v[20:23], v[124:127]
    v_mfma_f32_16x16x32_bf16 v[64:67], v[172:175], v[24:27], v[64:67]
    v_mfma_f32_16x16x32_bf16 v[80:83], v[176:179], v[24:27], v[80:83]
    v_mfma_f32_16x16x32_bf16 v[96:99], v[180:183], v[24:27], v[96:99]
    v_mfma_f32_16x16x32_bf16 v[112:115], v[184:187], v[24:27], v[112:115]
    v_mfma_f32_16x16x32_bf16 v[128:131], v[188:191], v[24:27], v[128:131]
    v_mfma_f32_16x16x32_bf16 v[68:71], v[172:175], v[28:31], v[68:71]
    v_mfma_f32_16x16x32_bf16 v[84:87], v[176:179], v[28:31], v[84:87]
    v_mfma_f32_16x16x32_bf16 v[100:103], v[180:183], v[28:31], v[100:103]
    v_mfma_f32_16x16x32_bf16 v[116:119], v[184:187], v[28:31], v[116:119]
    v_mfma_f32_16x16x32_bf16 v[132:135], v[188:191], v[28:31], v[132:135]
    ds_read_b128 v[16:19], v8 offset:8192
    ds_read_b128 v[20:23], v8 offset:10240
    ds_read_b128 v[24:27], v8 offset:12288
    ds_read_b128 v[28:31], v8 offset:14336
    s_waitcnt lgkmcnt(4)
    v_mfma_f32_16x16x32_bf16 v[56:59], v[192:195], v[232:235], v[56:59]
    v_mfma_f32_16x16x32_bf16 v[72:75], v[196:199], v[232:235], v[72:75]
    v_mfma_f32_16x16x32_bf16 v[88:91], v[200:203], v[232:235], v[88:91]
    v_mfma_f32_16x16x32_bf16 v[104:107], v[204:207], v[232:235], v[104:107]
    v_mfma_f32_16x16x32_bf16 v[120:123], v[208:211], v[232:235], v[120:123]
    v_mfma_f32_16x16x32_bf16 v[60:63], v[192:195], v[236:239], v[60:63]
    v_mfma_f32_16x16x32_bf16 v[76:79], v[196:199], v[236:239], v[76:79]
    v_mfma_f32_16x16x32_bf16 v[92:95], v[200:203], v[236:239], v[92:95]
    v_mfma_f32_16x16x32_bf16 v[108:111], v[204:207], v[236:239], v[108:111]
    v_mfma_f32_16x16x32_bf16 v[124:127], v[208:211], v[236:239], v[124:127]
    v_mfma_f32_16x16x32_bf16 v[64:67], v[192:195], v[240:243], v[64:67]
    v_mfma_f32_16x16x32_bf16 v[80:83], v[196:199], v[240:243], v[80:83]
    v_mfma_f32_16x16x32_bf16 v[96:99], v[200:203], v[240:243], v[96:99]
    v_mfma_f32_16x16x32_bf16 v[112:115], v[204:207], v[240:243], v[112:115]
    v_mfma_f32_16x16x32_bf16 v[128:131], v[208:211], v[240:243], v[128:131]
    v_mfma_f32_16x16x32_bf16 v[68:71], v[192:195], v[244:247], v[68:71]
    v_mfma_f32_16x16x32_bf16 v[84:87], v[196:199], v[244:247], v[84:87]
    v_mfma_f32_16x16x32_bf16 v[100:103], v[200:203], v[244:247], v[100:103]
    v_mfma_f32_16x16x32_bf16 v[116:119], v[204:207], v[244:247], v[116:119]
    v_mfma_f32_16x16x32_bf16 v[132:135], v[208:211], v[244:247], v[132:135]
    s_waitcnt lgkmcnt(0)
    s_and_b32 s8, s3, 1
    s_cmp_eq_u32 s8, 0
    s_cbranch_scc1 L_pr_k0
    v_mfma_f32_16x16x32_bf16 v[56:59], v[212:215], v[16:19], v[56:59]
    v_mfma_f32_16x16x32_bf16 v[72:75], v[216:219], v[16:19], v[72:75]
    v_mfma_f32_16x16x32_bf16 v[88:91], v[220:223], v[16:19], v[88:91]
    v_mfma_f32_16x16x32_bf16 v[104:107], v[224:227], v[16:19], v[104:107]
    v_mfma_f32_16x16x32_bf16 v[120:123], v[228:231], v[16:19], v[120:123]
    v_mfma_f32_16x16x32_bf16 v[60:63], v[212:215], v[20:23], v[60:63]
    v_mfma_f32_16x16x32_bf16 v[76:79], v[216:219], v[20:23], v[76:79]
    v_mfma_f32_16x16x32_bf16 v[92:95], v[220:223], v[20:23], v[92:95]
    v_mfma_f32_16x16x32_bf16 v[108:111], v[224:227], v[20:23], v[108:111]
    v_mfma_f32_16x16x32_bf16 v[124:127], v[228:231], v[20:23], v[124:127]
    v_mfma_f32_16x16x32_bf16 v[64:67], v[212:215], v[24:27], v[64:67]
    ds_write_b128 v9, v[56:59] offset:0
    v_mfma_f32_16x16x32_bf16 v[80:83], v[216:219], v[24:27], v[80:83]
    ds_write_b128 v9, v[72:75] offset:2048
    v_mfma_f32_16x16x32_bf16 v[96:99], v[220:223], v[24:27], v[96:99]
    ds_write_b128 v9, v[88:91] offset:4096
    v_mfma_f32_16x16x32_bf16 v[112:115], v[224:227], v[24:27], v[112:115]
    ds_write_b128 v9, v[104:107] offset:6144
    v_mfma_f32_16x16x32_bf16 v[128:131], v[228:231], v[24:27], v[128:131]
    ds_write_b128 v9, v[120:123] offset:8192
    v_mfma_f32_16x16x32_bf16 v[68:71], v[212:215], v[28:31], v[68:71]
    ds_write_b128 v9, v[60:63] offset:1024
    v_mfma_f32_16x16x32_bf16 v[84:87], v[216:219], v[28:31], v[84:87]
    ds_write_b128 v9, v[76:79] offset:3072
    v_mfma_f32_16x16x32_bf16 v[100:103], v[220:223], v[28:31], v[100:103]
    ds_write_b128 v9, v[92:95] offset:5120
    v_mfma_f32_16x16x32_bf16 v[116:119], v[224:227], v[28:31], v[116:119]
    ds_write_b128 v9, v[108:111] offset:7168
    v_mfma_f32_16x16x32_bf16 v[132:135], v[228:231], v[28:31], v[132:135]
    ds_write_b128 v9, v[124:127] offset:9216
    s_waitcnt lgkmcnt(0)
    s_barrier
    ds_read_b128 v[176:179], v1 offset:0
    ds_read_b128 v[180:183], v1 offset:1024
    ds_read_b128 v[184:187], v1 offset:2048
    ds_read_b128 v[188:191], v1 offset:3072
    ds_read_b128 v[192:195], v1 offset:4096
    ds_read_b128 v[196:199], v1 offset:5120
    ds_read_b128 v[200:203], v1 offset:6144
    ds_read_b128 v[204:207], v1 offset:7168
    ds_read_b128 v[208:211], v1 offset:8192
    ds_read_b128 v[212:215], v1 offset:9216
    s_waitcnt lgkmcnt(9)
    v_add_f32 v136, v64, v176
    v_add_f32 v137, v65, v177
    v_add_f32 v138, v66, v178
    v_add_f32 v139, v67, v179
    s_waitcnt lgkmcnt(8)
    v_add_f32 v140, v68, v180
    v_add_f32 v141, v69, v181
    v_add_f32 v142, v70, v182
    v_add_f32 v143, v71, v183
    s_waitcnt lgkmcnt(7)
    v_add_f32 v144, v80, v184
    v_add_f32 v145, v81, v185
    v_add_f32 v146, v82, v186
    v_add_f32 v147, v83, v187
    s_waitcnt lgkmcnt(6)
    v_add_f32 v148, v84, v188
    v_add_f32 v149, v85, v189
    v_add_f32 v150, v86, v190
    v_add_f32 v151, v87, v191
    s_waitcnt lgkmcnt(5)
    v_add_f32 v152, v96, v192
    v_add_f32 v153, v97, v193
    v_add_f32 v154, v98, v194
    v_add_f32 v155, v99, v195
    s_waitcnt lgkmcnt(4)
    v_add_f32 v156, v100, v196
    v_add_f32 v157, v101, v197
    v_add_f32 v158, v102, v198
    v_add_f32 v159, v103, v199
    s_waitcnt lgkmcnt(3)
    v_add_f32 v160, v112, v200
    v_add_f32 v161, v113, v201
    v_add_f32 v162, v114, v202
    v_add_f32 v163, v115, v203
    s_waitcnt lgkmcnt(2)
    v_add_f32 v164, v116, v204
    v_add_f32 v165, v117, v205
    v_add_f32 v166, v118, v206
    v_add_f32 v167, v119, v207
    s_waitcnt lgkmcnt(1)
    v_add_f32 v168, v128, v208
    v_add_f32 v169, v129, v209
    v_add_f32 v170, v130, v210
    v_add_f32 v171, v131, v211
    s_waitcnt lgkmcnt(0)
    v_add_f32 v172, v132, v212
    v_add_f32 v173, v133, v213
    v_add_f32 v174, v134, v214
    v_add_f32 v175, v135, v215
    s_branch L_pr_j
L_pr_k0:
    v_mfma_f32_16x16x32_bf16 v[64:67], v[212:215], v[24:27], v[64:67]
    v_mfma_f32_16x16x32_bf16 v[80:83], v[216:219], v[24:27], v[80:83]
    v_mfma_f32_16x16x32_bf16 v[96:99], v[220:223], v[24:27], v[96:99]
    v_mfma_f32_16x16x32_bf16 v[112:115], v[224:227], v[24:27], v[112:115]
    v_mfma_f32_16x16x32_bf16 v[128:131], v[228:231], v[24:27], v[128:131]
    v_mfma_f32_16x16x32_bf16 v[68:71], v[212:215], v[28:31], v[68:71]
    v_mfma_f32_16x16x32_bf16 v[84:87], v[216:219], v[28:31], v[84:87]
    v_mfma_f32_16x16x32_bf16 v[100:103], v[220:223], v[28:31], v[100:103]
    v_mfma_f32_16x16x32_bf16 v[116:119], v[224:227], v[28:31], v[116:119]
    v_mfma_f32_16x16x32_bf16 v[132:135], v[228:231], v[28:31], v[132:135]
    v_mfma_f32_16x16x32_bf16 v[56:59], v[212:215], v[16:19], v[56:59]
    ds_write_b128 v9, v[64:67] offset:0
    v_mfma_f32_16x16x32_bf16 v[72:75], v[216:219], v[16:19], v[72:75]
    ds_write_b128 v9, v[80:83] offset:2048
    v_mfma_f32_16x16x32_bf16 v[88:91], v[220:223], v[16:19], v[88:91]
    ds_write_b128 v9, v[96:99] offset:4096
    v_mfma_f32_16x16x32_bf16 v[104:107], v[224:227], v[16:19], v[104:107]
    ds_write_b128 v9, v[112:115] offset:6144
    v_mfma_f32_16x16x32_bf16 v[120:123], v[228:231], v[16:19], v[120:123]
    ds_write_b128 v9, v[128:131] offset:8192
    v_mfma_f32_16x16x32_bf16 v[60:63], v[212:215], v[20:23], v[60:63]
    ds_write_b128 v9, v[68:71] offset:1024
    v_mfma_f32_16x16x32_bf16 v[76:79], v[216:219], v[20:23], v[76:79]
    ds_write_b128 v9, v[84:87] offset:3072
    v_mfma_f32_16x16x32_bf16 v[92:95], v[220:223], v[20:23], v[92:95]
    ds_write_b128 v9, v[100:103] offset:5120
    v_mfma_f32_16x16x32_bf16 v[108:111], v[224:227], v[20:23], v[108:111]
    ds_write_b128 v9, v[116:119] offset:7168
    v_mfma_f32_16x16x32_bf16 v[124:127], v[228:231], v[20:23], v[124:127]
    ds_write_b128 v9, v[132:135] offset:9216
    s_waitcnt lgkmcnt(0)
    s_barrier
    ds_read_b128 v[176:179], v1 offset:0
    ds_read_b128 v[180:183], v1 offset:1024
    ds_read_b128 v[184:187], v1 offset:2048
    ds_read_b128 v[188:191], v1 offset:3072
    ds_read_b128 v[192:195], v1 offset:4096
    ds_read_b128 v[196:199], v1 offset:5120
    ds_read_b128 v[200:203], v1 offset:6144
    ds_read_b128 v[204:207], v1 offset:7168
    ds_read_b128 v[208:211], v1 offset:8192
    ds_read_b128 v[212:215], v1 offset:9216
    s_waitcnt lgkmcnt(9)
    v_add_f32 v136, v56, v176
    v_add_f32 v137, v57, v177
    v_add_f32 v138, v58, v178
    v_add_f32 v139, v59, v179
    s_waitcnt lgkmcnt(8)
    v_add_f32 v140, v60, v180
    v_add_f32 v141, v61, v181
    v_add_f32 v142, v62, v182
    v_add_f32 v143, v63, v183
    s_waitcnt lgkmcnt(7)
    v_add_f32 v144, v72, v184
    v_add_f32 v145, v73, v185
    v_add_f32 v146, v74, v186
    v_add_f32 v147, v75, v187
    s_waitcnt lgkmcnt(6)
    v_add_f32 v148, v76, v188
    v_add_f32 v149, v77, v189
    v_add_f32 v150, v78, v190
    v_add_f32 v151, v79, v191
    s_waitcnt lgkmcnt(5)
    v_add_f32 v152, v88, v192
    v_add_f32 v153, v89, v193
    v_add_f32 v154, v90, v194
    v_add_f32 v155, v91, v195
    s_waitcnt lgkmcnt(4)
    v_add_f32 v156, v92, v196
    v_add_f32 v157, v93, v197
    v_add_f32 v158, v94, v198
    v_add_f32 v159, v95, v199
    s_waitcnt lgkmcnt(3)
    v_add_f32 v160, v104, v200
    v_add_f32 v161, v105, v201
    v_add_f32 v162, v106, v202
    v_add_f32 v163, v107, v203
    s_waitcnt lgkmcnt(2)
    v_add_f32 v164, v108, v204
    v_add_f32 v165, v109, v205
    v_add_f32 v166, v110, v206
    v_add_f32 v167, v111, v207
    s_waitcnt lgkmcnt(1)
    v_add_f32 v168, v120, v208
    v_add_f32 v169, v121, v209
    v_add_f32 v170, v122, v210
    v_add_f32 v171, v123, v211
    s_waitcnt lgkmcnt(0)
    v_add_f32 v172, v124, v212
    v_add_f32 v173, v125, v213
    v_add_f32 v174, v126, v214
    v_add_f32 v175, v127, v215
L_pr_j:
    s_lshl_b32 s10, s5, 2
    s_add_u32 s10, s10, s7
    s_lshl_b32 s10, s10, 3
    s_add_u32 s11, s10, s4
    s_mul_i32 s11, s11, 20480
    s_add_u32 s11, s11, 8388608
    s_add_u32 s48, s30, s11
    s_addc_u32 s49, s31, 0
    s_mov_b32 s50, 20480
    s_mov_b32 s51, 0x20000
    v_lshlrev_b32 v7, 4, v2
    v_lshlrev_b32 v8, 3, v2
    s_mul_i32 s14, s3, 5120
    s_lshr_b32 s11, s10, 3
    s_lshl_b32 s11, s11, 10
    s_add_u32 s11, s11, 33619968
    s_add_u32 s40, s30, s11
    s_addc_u32 s41, s31, 0
    s_mov_b32 s42, 1024
    s_mov_b32 s43, 0x20000
    v_cvt_pk_bf16_f32 v16, v136, v137
    v_cvt_pk_bf16_f32 v17, v138, v139
    v_cvt_pk_bf16_f32 v18, v144, v145
    v_cvt_pk_bf16_f32 v19, v146, v147
    s_add_u32 s11, s14, 0
    buffer_store_dwordx4 v[16:19], v7, s[48:51], s11 offen sc1
    v_cvt_pk_bf16_f32 v20, v152, v153
    v_cvt_pk_bf16_f32 v21, v154, v155
    v_cvt_pk_bf16_f32 v22, v160, v161
    v_cvt_pk_bf16_f32 v23, v162, v163
    s_add_u32 s11, s14, 1024
    buffer_store_dwordx4 v[20:23], v7, s[48:51], s11 offen sc1
    v_cvt_pk_bf16_f32 v24, v168, v169
    v_cvt_pk_bf16_f32 v25, v170, v171
    s_add_u32 s11, s14, 2048
    buffer_store_dwordx2 v[24:25], v8, s[48:51], s11 offen sc1
    v_cvt_pk_bf16_f32 v28, v140, v141
    v_cvt_pk_bf16_f32 v29, v142, v143
    v_cvt_pk_bf16_f32 v30, v148, v149
    v_cvt_pk_bf16_f32 v31, v150, v151
    s_add_u32 s11, s14, 2560
    buffer_store_dwordx4 v[28:31], v7, s[48:51], s11 offen sc1
    v_cvt_pk_bf16_f32 v16, v156, v157
    v_cvt_pk_bf16_f32 v17, v158, v159
    v_cvt_pk_bf16_f32 v18, v164, v165
    v_cvt_pk_bf16_f32 v19, v166, v167
    s_add_u32 s11, s14, 3584
    buffer_store_dwordx4 v[16:19], v7, s[48:51], s11 offen sc1
    v_cvt_pk_bf16_f32 v20, v172, v173
    v_cvt_pk_bf16_f32 v21, v174, v175
    s_add_u32 s11, s14, 4608
    buffer_store_dwordx2 v[20:21], v8, s[48:51], s11 offen sc1
    s_and_b32 s8, s3, 1
    s_lshl_b32 s8, s8, 2
    s_lshr_b32 s9, s3, 1
    s_add_u32 s8, s8, s9
    s_lshl_b32 s8, s8, 7
    s_lshl_b32 s9, s4, 3
    s_add_u32 s8, s8, s9
    v_lshlrev_b32 v51, 8, v2
    v_add_u32 v51, s8, v51
    s_lshr_b32 s8, s4, 2
    s_and_b32 s9, s4, 1
    s_lshl_b32 s9, s9, 1
    s_or_b32 s8, s8, s9
    s_lshl_b32 s9, s4, 7
    v_lshlrev_b32 v54, 3, v2
    v_add_u32 v54, s9, v54
    s_lshl_b32 s8, s8, 1
    s_bfe_u32 s9, s4, 0x10001
    s_add_u32 s8, s8, s9
    s_mul_i32 s9, s8, 2560
    s_lshl_b32 s8, s3, 10
    s_add_u32 s9, s9, s8
    s_lshr_b32 s10, s10, 3
    s_mul_i32 s8, s10, 163840
    s_add_u32 s8, s8, 8388608
    s_add_u32 s36, s30, s8
    s_addc_u32 s37, s31, 0
    s_mov_b32 s38, 163840
    s_mov_b32 s39, 0x20000
    s_mov_b32 s44, s26
    s_mov_b32 s45, s27
    s_mov_b32 s46, 655360
    s_mov_b32 s47, 0x20000
    s_lshr_b32 s10, s4, 1
    s_lshl_b32 s10, s10, 4
    s_lshl_b32 s12, s5, 6
    s_add_u32 s12, s12, s10
    s_mul_i32 s12, s12, 1280
    s_mul_i32 s13, s7, 320
    s_add_u32 s12, s12, s13
    s_and_b32 s10, s4, 1
    s_mul_i32 s10, s10, 160
    s_add_u32 s12, s12, s10
    s_lshl_b32 s10, s3, 6
    s_add_u32 s12, s12, s10
    v_and_b32 v4, 15, v2
    v_lshrrev_b32 v3, 4, v2
    v_mul_u32_u24 v4, 1280, v4
    v_lshl_add_u32 v4, v3, 3, v4
    s_waitcnt vmcnt(0)
    s_mov_b64 exec, 3
    buffer_store_dwordx2 v[48:49], v51, s[40:43], 0 offen sc1
    s_mov_b64 exec, -1
    s_cmp_eq_u32 s3, 3
    s_cbranch_scc1 L_fin
    s_cmp_lg_u32 s3, 0
    s_cbranch_scc1 L_poll2_skip
    s_mov_b64 exec, 0xff
    s_mov_b32 s99, 0x40000
    buffer_load_dwordx2 v[52:53], v54, s[40:43], 0 offen sc1
    buffer_load_dwordx2 v[238:239], v54, s[40:43], 0 offen sc1
L_poll2:
    buffer_load_dwordx2 v[240:241], v54, s[40:43], 0 offen sc1
    s_waitcnt vmcnt(2)
    v_cmp_ne_u64 vcc, s[52:53], v[52:53]
    s_cbranch_vccz L_poll2_x
    buffer_load_dwordx2 v[52:53], v54, s[40:43], 0 offen sc1
    s_waitcnt vmcnt(2)
    v_cmp_ne_u64 vcc, s[52:53], v[238:239]
    s_cbranch_vccz L_poll2_x
    buffer_load_dwordx2 v[238:239], v54, s[40:43], 0 offen sc1
    s_waitcnt vmcnt(2)
    v_cmp_ne_u64 vcc, s[52:53], v[240:241]
    s_cbranch_vccz L_poll2_x
    s_sub_u32 s99, s99, 1
    s_cbranch_scc0 L_poll2
L_poll2_x:
    s_waitcnt vmcnt(0)
    s_mov_b64 exec, -1
L_poll2_skip:
    s_barrier
    s_cmp_eq_u32 s3, 2
    s_cbranch_scc1 L_red_single
    s_add_u32 s10, s9, 0
    buffer_load_dwordx4 v[64:67], v7, s[36:39], s10 offen sc1
    s_add_u32 s10, s9, 20480
    buffer_load_dwordx4 v[68:71], v7, s[36:39], s10 offen sc1
    s_add_u32 s10, s9, 40960
    buffer_load_dwordx4 v[72:75], v7, s[36:39], s10 offen sc1
    s_add_u32 s10, s9, 61440
    buffer_load_dwordx4 v[76:79], v7, s[36:39], s10 offen sc1
    s_add_u32 s10, s9, 81920
    buffer_load_dwordx4 v[80:83], v7, s[36:39], s10 offen sc1
    s_add_u32 s10, s9, 102400
    buffer_load_dwordx4 v[84:87], v7, s[36:39], s10 offen sc1
    s_add_u32 s10, s9, 122880
    buffer_load_dwordx4 v[88:91], v7, s[36:39], s10 offen sc1
    s_add_u32 s10, s9, 143360
    buffer_load_dwordx4 v[92:95], v7, s[36:39], s10 offen sc1
    s_waitcnt vmcnt(7)
    v_lshlrev_b32 v16, 16, v64
    v_and_b32 v17, 0xffff0000, v64
    v_lshlrev_b32 v18, 16, v65
    v_and_b32 v19, 0xffff0000, v65
    v_lshlrev_b32 v20, 16, v66
    v_and_b32 v21, 0xffff0000, v66
    v_lshlrev_b32 v22, 16, v67
    v_and_b32 v23, 0xffff0000, v67
    s_waitcnt vmcnt(6)
    v_lshlrev_b32 v24, 16, v68
    v_and_b32 v25, 0xffff0000, v68
    v_add_f32 v16, v16, v24
    v_add_f32 v17, v17, v25
    v_lshlrev_b32 v24, 16, v69
    v_and_b32 v25, 0xffff0000, v69
    v_add_f32 v18, v18, v24
    v_add_f32 v19, v19, v25
    v_lshlrev_b32 v24, 16, v70
    v_and_b32 v25, 0xffff0000, v70
    v_add_f32 v20, v20, v24
    v_add_f32 v21, v21, v25
    v_lshlrev_b32 v24, 16, v71
    v_and_b32 v25, 0xffff0000, v71
    v_add_f32 v22, v22, v24
    v_add_f32 v23, v23, v25
    s_waitcnt vmcnt(5)
    v_lshlrev_b32 v24, 16, v72
    v_and_b32 v25, 0xffff0000, v72
    v_add_f32 v16, v16, v24
    v_add_f32 v17, v17, v25
    v_lshlrev_b32 v24, 16, v73
    v_and_b32 v25, 0xffff0000, v73
    v_add_f32 v18, v18, v24
    v_add_f32 v19, v19, v25
    v_lshlrev_b32 v24, 16, v74
    v_and_b32 v25, 0xffff0000, v74
    v_add_f32 v20, v20, v24
    v_add_f32 v21, v21, v25
    v_lshlrev_b32 v24, 16, v75
    v_and_b32 v25, 0xffff0000, v75
    v_add_f32 v22, v22, v24
    v_add_f32 v23, v23, v25
    s_waitcnt vmcnt(4)
    v_lshlrev_b32 v24, 16, v76
    v_and_b32 v25, 0xffff0000, v76
    v_add_f32 v16, v16, v24
    v_add_f32 v17, v17, v25
    v_lshlrev_b32 v24, 16, v77
    v_and_b32 v25, 0xffff0000, v77
    v_add_f32 v18, v18, v24
    v_add_f32 v19, v19, v25
    v_lshlrev_b32 v24, 16, v78
    v_and_b32 v25, 0xffff0000, v78
    v_add_f32 v20, v20, v24
    v_add_f32 v21, v21, v25
    v_lshlrev_b32 v24, 16, v79
    v_and_b32 v25, 0xffff0000, v79
    v_add_f32 v22, v22, v24
    v_add_f32 v23, v23, v25
    s_waitcnt vmcnt(3)
    v_lshlrev_b32 v24, 16, v80
    v_and_b32 v25, 0xffff0000, v80
    v_add_f32 v16, v16, v24
    v_add_f32 v17, v17, v25
    v_lshlrev_b32 v24, 16, v81
    v_and_b32 v25, 0xffff0000, v81
    v_add_f32 v18, v18, v24
    v_add_f32 v19, v19, v25
    v_lshlrev_b32 v24, 16, v82
    v_and_b32 v25, 0xffff0000, v82
    v_add_f32 v20, v20, v24
    v_add_f32 v21, v21, v25
    v_lshlrev_b32 v24, 16, v83
    v_and_b32 v25, 0xffff0000, v83
    v_add_f32 v22, v22, v24
    v_add_f32 v23, v23, v25
    s_waitcnt vmcnt(2)
    v_lshlrev_b32 v24, 16, v84
    v_and_b32 v25, 0xffff0000, v84
    v_add_f32 v16, v16, v24
    v_add_f32 v17, v17, v25
    v_lshlrev_b32 v24, 16, v85
    v_and_b32 v25, 0xffff0000, v85
    v_add_f32 v18, v18, v24
    v_add_f32 v19, v19, v25
    v_lshlrev_b32 v24, 16, v86
    v_and_b32 v25, 0xffff0000, v86
    v_add_f32 v20, v20, v24
    v_add_f32 v21, v21, v25
    v_lshlrev_b32 v24, 16, v87
    v_and_b32 v25, 0xffff0000, v87
    v_add_f32 v22, v22, v24
    v_add_f32 v23, v23, v25
    s_waitcnt vmcnt(1)
    v_lshlrev_b32 v24, 16, v88
    v_and_b32 v25, 0xffff0000, v88
    v_add_f32 v16, v16, v24
    v_add_f32 v17, v17, v25
    v_lshlrev_b32 v24, 16, v89
    v_and_b32 v25, 0xffff0000, v89
    v_add_f32 v18, v18, v24
    v_add_f32 v19, v19, v25
    v_lshlrev_b32 v24, 16, v90
    v_and_b32 v25, 0xffff0000, v90
    v_add_f32 v20, v20, v24
    v_add_f32 v21, v21, v25
    v_lshlrev_b32 v24, 16, v91
    v_and_b32 v25, 0xffff0000, v91
    v_add_f32 v22, v22, v24
    v_add_f32 v23, v23, v25
    s_waitcnt vmcnt(0)
    v_lshlrev_b32 v24, 16, v92
    v_and_b32 v25, 0xffff0000, v92
    v_add_f32 v16, v16, v24
    v_add_f32 v17, v17, v25
    v_lshlrev_b32 v24, 16, v93
    v_and_b32 v25, 0xffff0000, v93
    v_add_f32 v18, v18, v24
    v_add_f32 v19, v19, v25
    v_lshlrev_b32 v24, 16, v94
    v_and_b32 v25, 0xffff0000, v94
    v_add_f32 v20, v20, v24
    v_add_f32 v21, v21, v25
    v_lshlrev_b32 v24, 16, v95
    v_and_b32 v25, 0xffff0000, v95
    v_add_f32 v22, v22, v24
    v_add_f32 v23, v23, v25
    v_cvt_pk_bf16_f32 v26, v16, v17
    v_cvt_pk_bf16_f32 v27, v18, v19
    buffer_store_dwordx2 v[26:27], v4, s[44:47], s12 offen offset:0
    v_cvt_pk_bf16_f32 v28, v20, v21
    v_cvt_pk_bf16_f32 v29, v22, v23
    buffer_store_dwordx2 v[28:29], v4, s[44:47], s12 offen offset:32
    s_branch L_fin
L_red_single:
    s_add_u32 s10, s9, 0
    buffer_load_dwordx2 v[64:65], v8, s[36:39], s10 offen sc1
    s_add_u32 s10, s9, 20480
    buffer_load_dwordx2 v[68:69], v8, s[36:39], s10 offen sc1
    s_add_u32 s10, s9, 40960
    buffer_load_dwordx2 v[72:73], v8, s[36:39], s10 offen sc1
    s_add_u32 s10, s9, 61440
    buffer_load_dwordx2 v[76:77], v8, s[36:39], s10 offen sc1
    s_add_u32 s10, s9, 81920
    buffer_load_dwordx2 v[80:81], v8, s[36:39], s10 offen sc1
    s_add_u32 s10, s9, 102400
    buffer_load_dwordx2 v[84:85], v8, s[36:39], s10 offen sc1
    s_add_u32 s10, s9, 122880
    buffer_load_dwordx2 v[88:89], v8, s[36:39], s10 offen sc1
    s_add_u32 s10, s9, 143360
    buffer_load_dwordx2 v[92:93], v8, s[36:39], s10 offen sc1
    s_waitcnt vmcnt(7)
    v_lshlrev_b32 v16, 16, v64
    v_and_b32 v17, 0xffff0000, v64
    v_lshlrev_b32 v18, 16, v65
    v_and_b32 v19, 0xffff0000, v65
    s_waitcnt vmcnt(6)
    v_lshlrev_b32 v24, 16, v68
    v_and_b32 v25, 0xffff0000, v68
    v_add_f32 v16, v16, v24
    v_add_f32 v17, v17, v25
    v_lshlrev_b32 v24, 16, v69
    v_and_b32 v25, 0xffff0000, v69
    v_add_f32 v18, v18, v24
    v_add_f32 v19, v19, v25
    s_waitcnt vmcnt(5)
    v_lshlrev_b32 v24, 16, v72
    v_and_b32 v25, 0xffff0000, v72
    v_add_f32 v16, v16, v24
    v_add_f32 v17, v17, v25
    v_lshlrev_b32 v24, 16, v73
    v_and_b32 v25, 0xffff0000, v73
    v_add_f32 v18, v18, v24
    v_add_f32 v19, v19, v25
    s_waitcnt vmcnt(4)
    v_lshlrev_b32 v24, 16, v76
    v_and_b32 v25, 0xffff0000, v76
    v_add_f32 v16, v16, v24
    v_add_f32 v17, v17, v25
    v_lshlrev_b32 v24, 16, v77
    v_and_b32 v25, 0xffff0000, v77
    v_add_f32 v18, v18, v24
    v_add_f32 v19, v19, v25
    s_waitcnt vmcnt(3)
    v_lshlrev_b32 v24, 16, v80
    v_and_b32 v25, 0xffff0000, v80
    v_add_f32 v16, v16, v24
    v_add_f32 v17, v17, v25
    v_lshlrev_b32 v24, 16, v81
    v_and_b32 v25, 0xffff0000, v81
    v_add_f32 v18, v18, v24
    v_add_f32 v19, v19, v25
    s_waitcnt vmcnt(2)
    v_lshlrev_b32 v24, 16, v84
    v_and_b32 v25, 0xffff0000, v84
    v_add_f32 v16, v16, v24
    v_add_f32 v17, v17, v25
    v_lshlrev_b32 v24, 16, v85
    v_and_b32 v25, 0xffff0000, v85
    v_add_f32 v18, v18, v24
    v_add_f32 v19, v19, v25
    s_waitcnt vmcnt(1)
    v_lshlrev_b32 v24, 16, v88
    v_and_b32 v25, 0xffff0000, v88
    v_add_f32 v16, v16, v24
    v_add_f32 v17, v17, v25
    v_lshlrev_b32 v24, 16, v89
    v_and_b32 v25, 0xffff0000, v89
    v_add_f32 v18, v18, v24
    v_add_f32 v19, v19, v25
    s_waitcnt vmcnt(0)
    v_lshlrev_b32 v24, 16, v92
    v_and_b32 v25, 0xffff0000, v92
    v_add_f32 v16, v16, v24
    v_add_f32 v17, v17, v25
    v_lshlrev_b32 v24, 16, v93
    v_and_b32 v25, 0xffff0000, v93
    v_add_f32 v18, v18, v24
    v_add_f32 v19, v19, v25
    v_cvt_pk_bf16_f32 v26, v16, v17
    v_cvt_pk_bf16_f32 v27, v18, v19
    buffer_store_dwordx2 v[26:27], v4, s[44:47], s12 offen offset:0
L_fin:
    s_endpgm
L_loaders:
    s_cmp_eq_u32 s3, 6
    s_cbranch_scc1 L_ldx
    s_cmp_eq_u32 s3, 7
    s_cbranch_scc1 L_ldkv
    v_add_u32 v7, 0, v2
    v_mul_u32_u24 v8, 2731, v7
    v_lshrrev_b32 v8, 16, v8
    v_mul_u32_u24 v9, 24, v8
    v_sub_u32 v9, v7, v9
    v_and_b32 v7, 2, v8
    v_xor_b32 v9, v9, v7
    v_mul_u32_u24 v8, 12288, v8
    v_lshl_add_u32 v10, v9, 4, v8
    v_xor_b32 v13, 64, v10
    v_add_u32 v13, 98304, v13
    v_add_u32 v7, 64, v2
    v_mul_u32_u24 v8, 2731, v7
    v_lshrrev_b32 v8, 16, v8
    v_mul_u32_u24 v9, 24, v8
    v_sub_u32 v9, v7, v9
    v_and_b32 v7, 2, v8
    v_xor_b32 v9, v9, v7
    v_mul_u32_u24 v8, 12288, v8
    v_lshl_add_u32 v11, v9, 4, v8
    v_xor_b32 v14, 64, v11
    v_add_u32 v14, 97280, v14
    v_subrev_u32 v11, 1024, v11
    v_add_u32 v7, 128, v2
    v_mul_u32_u24 v8, 2731, v7
    v_lshrrev_b32 v8, 16, v8
    v_mul_u32_u24 v9, 24, v8
    v_sub_u32 v9, v7, v9
    v_and_b32 v7, 2, v8
    v_xor_b32 v9, v9, v7
    v_mul_u32_u24 v8, 12288, v8
    v_lshl_add_u32 v12, v9, 4, v8
    v_xor_b32 v15, 64, v12
    v_add_u32 v15, 96256, v15
    v_subrev_u32 v12, 2048, v12
    s_sub_u32 s8, s3, 4
    s_mul_i32 s9, s8, 196608
    s_mul_i32 s10, s6, 384
    s_add_u32 s9, s9, s10
    s_add_u32 s33, s9, 7864320
    s_mul_i32 s10, s61, 393216
    s_add_u32 s9, s9, s10
    s_mul_i32 s11, s8, 6144
    s_add_u32 s12, s11, 131072
    s_add_u32 s15, s11, 163840
    s_waitcnt lgkmcnt(0)
    s_mov_b32 s36, s22
    s_mov_b32 s37, s23
    s_mov_b32 s38, 7864320
    s_mov_b32 s39, 0x20000
    s_mov_b32 s13, 4
L_w_pro:
    s_mov_b32 m0, s12
    s_add_u32 s10, s12, 3072
    buffer_load_dwordx4 v10, s[36:39], s9 offen  lds
    buffer_load_dwordx4 v11, s[36:39], s9 offen offset:1024  lds
    buffer_load_dwordx4 v12, s[36:39], s9 offen offset:2048  lds
    s_mov_b32 m0, s10
    s_add_u32 s12, s12, 16384
    buffer_load_dwordx4 v13, s[36:39], s9 offen  lds
    buffer_load_dwordx4 v14, s[36:39], s9 offen offset:1024  lds
    buffer_load_dwordx4 v15, s[36:39], s9 offen offset:2048  lds
    s_add_u32 s9, s9, 393216
    s_cmp_ge_u32 s12, s15
    s_cselect_b32 s14, 114688, 0
    s_sub_u32 s12, s12, s14
    s_cmp_ge_u32 s9, s33
    s_cselect_b32 s14, 7864320, 0
    s_sub_u32 s9, s9, s14
    s_sub_u32 s13, s13, 1
    s_cmp_lg_u32 s13, 0
    s_cbranch_scc1 L_w_pro
    s_mov_b32 s44, s24
    s_mov_b32 s45, s25
    s_mov_b32 s46, 7864320
    s_mov_b32 s47, 0x20000
    v_add_u32 v7, 0, v2
    v_mul_u32_u24 v8, 3277, v7
    v_lshrrev_b32 v8, 16, v8
    v_mul_u32_u24 v9, 20, v8
    v_sub_u32 v9, v7, v9
    v_lshrrev_b32 v7, 3, v8
    v_lshlrev_b32 v7, 1, v7
    v_xor_b32 v9, v9, v7
    v_mul_u32_u24 v8, 1280, v8
    v_lshl_add_u32 v16, v9, 4, v8
    v_add_u32 v7, 64, v2
    v_mul_u32_u24 v8, 3277, v7
    v_lshrrev_b32 v8, 16, v8
    v_mul_u32_u24 v9, 20, v8
    v_sub_u32 v9, v7, v9
    v_lshrrev_b32 v7, 3, v8
    v_lshlrev_b32 v7, 1, v7
    v_xor_b32 v9, v9, v7
    v_mul_u32_u24 v8, 1280, v8
    v_lshl_add_u32 v17, v9, 4, v8
    v_subrev_u32 v17, 1024, v17
    v_add_u32 v7, 128, v2
    v_mul_u32_u24 v8, 3277, v7
    v_lshrrev_b32 v8, 16, v8
    v_mul_u32_u24 v9, 20, v8
    v_sub_u32 v9, v7, v9
    v_lshrrev_b32 v7, 3, v8
    v_lshlrev_b32 v7, 1, v7
    v_xor_b32 v9, v9, v7
    v_mul_u32_u24 v8, 1280, v8
    v_lshl_add_u32 v18, v9, 4, v8
    v_subrev_u32 v18, 2048, v18
    v_add_u32 v7, 192, v2
    v_mul_u32_u24 v8, 3277, v7
    v_lshrrev_b32 v8, 16, v8
    v_mul_u32_u24 v9, 20, v8
    v_sub_u32 v9, v7, v9
    v_lshrrev_b32 v7, 3, v8
    v_lshlrev_b32 v7, 1, v7
    v_xor_b32 v9, v9, v7
    v_mul_u32_u24 v8, 1280, v8
    v_lshl_add_u32 v19, v9, 4, v8
    v_add_u32 v7, 256, v2
    v_mul_u32_u24 v8, 3277, v7
    v_lshrrev_b32 v8, 16, v8
    v_mul_u32_u24 v9, 20, v8
    v_sub_u32 v9, v7, v9
    v_lshrrev_b32 v7, 3, v8
    v_lshlrev_b32 v7, 1, v7
    v_xor_b32 v9, v9, v7
    v_mul_u32_u24 v8, 1280, v8
    v_lshl_add_u32 v20, v9, 4, v8
    v_subrev_u32 v20, 1024, v20
    s_mul_i32 s34, s4, 768
    s_lshl_b32 s10, s8, 4
    s_add_u32 s34, s34, s10
    s_mul_i32 s34, s34, 1280
    s_mul_i32 s10, s7, 320
    s_add_u32 s34, s34, s10
    s_add_u32 s35, s34, 983040
    s_mul_i32 s10, s94, 245760
    s_add_u32 s34, s34, s10
    s_mul_i32 s11, s8, 5120
    s_add_u32 s50, s11, 118784
    s_add_u32 s51, s11, 159744
    s_mov_b32 s13, 7
L_w_loop:
    s_waitcnt vmcnt(12)
    s_barrier
    s_mov_b32 m0, s12
    s_add_u32 s10, s12, 3072
    buffer_load_dwordx4 v10, s[36:39], s9 offen  lds
    buffer_load_dwordx4 v11, s[36:39], s9 offen offset:1024  lds
    buffer_load_dwordx4 v12, s[36:39], s9 offen offset:2048  lds
    s_mov_b32 m0, s10
    s_add_u32 s12, s12, 16384
    buffer_load_dwordx4 v13, s[36:39], s9 offen  lds
    buffer_load_dwordx4 v14, s[36:39], s9 offen offset:1024  lds
    buffer_load_dwordx4 v15, s[36:39], s9 offen offset:2048  lds
    s_add_u32 s9, s9, 393216
    s_cmp_ge_u32 s12, s15
    s_cselect_b32 s14, 114688, 0
    s_sub_u32 s12, s12, s14
    s_cmp_ge_u32 s9, s33
    s_cselect_b32 s14, 7864320, 0
    s_sub_u32 s9, s9, s14
    s_mov_b32 m0, s12
    s_add_u32 s10, s12, 3072
    buffer_load_dwordx4 v10, s[36:39], s9 offen  lds
    buffer_load_dwordx4 v11, s[36:39], s9 offen offset:1024  lds
    buffer_load_dwordx4 v12, s[36:39], s9 offen offset:2048  lds
    s_mov_b32 m0, s10
    s_add_u32 s12, s12, 16384
    buffer_load_dwordx4 v13, s[36:39], s9 offen  lds
    buffer_load_dwordx4 v14, s[36:39], s9 offen offset:1024  lds
    buffer_load_dwordx4 v15, s[36:39], s9 offen offset:2048  lds
    s_add_u32 s9, s9, 393216
    s_cmp_ge_u32 s12, s15
    s_cselect_b32 s14, 114688, 0
    s_sub_u32 s12, s12, s14
    s_cmp_ge_u32 s9, s33
    s_cselect_b32 s14, 7864320, 0
    s_sub_u32 s9, s9, s14
    s_sub_u32 s13, s13, 1
    s_cmp_lg_u32 s13, 0
    s_cbranch_scc1 L_w_loop
    s_waitcnt vmcnt(12)
    s_barrier
    s_mov_b32 m0, s12
    s_add_u32 s10, s12, 3072
    buffer_load_dwordx4 v10, s[36:39], s9 offen  lds
    buffer_load_dwordx4 v11, s[36:39], s9 offen offset:1024  lds
    buffer_load_dwordx4 v12, s[36:39], s9 offen offset:2048  lds
    s_mov_b32 m0, s10
    s_add_u32 s12, s12, 16384
    buffer_load_dwordx4 v13, s[36:39], s9 offen  lds
    buffer_load_dwordx4 v14, s[36:39], s9 offen offset:1024  lds
    buffer_load_dwordx4 v15, s[36:39], s9 offen offset:2048  lds
    s_add_u32 s9, s9, 393216
    s_cmp_ge_u32 s12, s15
    s_cselect_b32 s14, 114688, 0
    s_sub_u32 s12, s12, s14
    s_cmp_ge_u32 s9, s33
    s_cselect_b32 s14, 7864320, 0
    s_sub_u32 s9, s9, s14
    s_mov_b32 m0, s12
    s_add_u32 s10, s12, 3072
    buffer_load_dwordx4 v10, s[36:39], s9 offen  lds
    buffer_load_dwordx4 v11, s[36:39], s9 offen offset:1024  lds
    buffer_load_dwordx4 v12, s[36:39], s9 offen offset:2048  lds
    s_mov_b32 m0, s10
    s_add_u32 s12, s12, 16384
    buffer_load_dwordx4 v13, s[36:39], s9 offen  lds
    buffer_load_dwordx4 v14, s[36:39], s9 offen offset:1024  lds
    buffer_load_dwordx4 v15, s[36:39], s9 offen offset:2048  lds
    s_add_u32 s9, s9, 393216
    s_cmp_ge_u32 s12, s15
    s_cselect_b32 s14, 114688, 0
    s_sub_u32 s12, s12, s14
    s_cmp_ge_u32 s9, s33
    s_cselect_b32 s14, 7864320, 0
    s_sub_u32 s9, s9, s14
    s_mov_b32 m0, s50
    s_add_u32 s10, s50, 3072
    buffer_load_dwordx4 v16, s[44:47], s34 offen  lds
    buffer_load_dwordx4 v17, s[44:47], s34 offen offset:1024  lds
    buffer_load_dwordx4 v18, s[44:47], s34 offen offset:2048  lds
    s_mov_b32 m0, s10
    s_add_u32 s50, s50, 10240
    buffer_load_dwordx4 v19, s[44:47], s34 offen  lds
    buffer_load_dwordx4 v20, s[44:47], s34 offen offset:1024  lds
    s_add_u32 s34, s34, 40960
    s_cmp_ge_u32 s50, s51
    s_cselect_b32 s14, 61440, 0
    s_sub_u32 s50, s50, s14
    s_cmp_ge_u32 s34, s35
    s_cselect_b32 s14, 983040, 0
    s_sub_u32 s34, s34, s14
    s_waitcnt vmcnt(17)
    s_barrier
    s_mov_b32 m0, s50
    s_add_u32 s10, s50, 3072
    buffer_load_dwordx4 v16, s[44:47], s34 offen  lds
    buffer_load_dwordx4 v17, s[44:47], s34 offen offset:1024  lds
    buffer_load_dwordx4 v18, s[44:47], s34 offen offset:2048  lds
    s_mov_b32 m0, s10
    s_add_u32 s50, s50, 10240
    buffer_load_dwordx4 v19, s[44:47], s34 offen  lds
    buffer_load_dwordx4 v20, s[44:47], s34 offen offset:1024  lds
    s_add_u32 s34, s34, 40960
    s_cmp_ge_u32 s50, s51
    s_cselect_b32 s14, 61440, 0
    s_sub_u32 s50, s50, s14
    s_cmp_ge_u32 s34, s35
    s_cselect_b32 s14, 983040, 0
    s_sub_u32 s34, s34, s14
    s_mov_b32 m0, s50
    s_add_u32 s10, s50, 3072
    buffer_load_dwordx4 v16, s[44:47], s34 offen  lds
    buffer_load_dwordx4 v17, s[44:47], s34 offen offset:1024  lds
    buffer_load_dwordx4 v18, s[44:47], s34 offen offset:2048  lds
    s_mov_b32 m0, s10
    s_add_u32 s50, s50, 10240
    buffer_load_dwordx4 v19, s[44:47], s34 offen  lds
    buffer_load_dwordx4 v20, s[44:47], s34 offen offset:1024  lds
    s_add_u32 s34, s34, 40960
    s_cmp_ge_u32 s50, s51
    s_cselect_b32 s14, 61440, 0
    s_sub_u32 s50, s50, s14
    s_cmp_ge_u32 s34, s35
    s_cselect_b32 s14, 983040, 0
    s_sub_u32 s34, s34, s14
    s_mov_b32 m0, s50
    s_add_u32 s10, s50, 3072
    buffer_load_dwordx4 v16, s[44:47], s34 offen  lds
    buffer_load_dwordx4 v17, s[44:47], s34 offen offset:1024  lds
    buffer_load_dwordx4 v18, s[44:47], s34 offen offset:2048  lds
    s_mov_b32 m0, s10
    s_add_u32 s50, s50, 10240
    buffer_load_dwordx4 v19, s[44:47], s34 offen  lds
    buffer_load_dwordx4 v20, s[44:47], s34 offen offset:1024  lds
    s_add_u32 s34, s34, 40960
    s_cmp_ge_u32 s50, s51
    s_cselect_b32 s14, 61440, 0
    s_sub_u32 s50, s50, s14
    s_cmp_ge_u32 s34, s35
    s_cselect_b32 s14, 983040, 0
    s_sub_u32 s34, s34, s14
    s_waitcnt vmcnt(20)
    s_barrier
    s_barrier
    s_mov_b32 m0, s50
    s_add_u32 s10, s50, 3072
    buffer_load_dwordx4 v16, s[44:47], s34 offen  lds
    buffer_load_dwordx4 v17, s[44:47], s34 offen offset:1024  lds
    buffer_load_dwordx4 v18, s[44:47], s34 offen offset:2048  lds
    s_mov_b32 m0, s10
    s_add_u32 s50, s50, 10240
    buffer_load_dwordx4 v19, s[44:47], s34 offen  lds
    buffer_load_dwordx4 v20, s[44:47], s34 offen offset:1024  lds
    s_add_u32 s34, s34, 40960
    s_cmp_ge_u32 s50, s51
    s_cselect_b32 s14, 61440, 0
    s_sub_u32 s50, s50, s14
    s_cmp_ge_u32 s34, s35
    s_cselect_b32 s14, 983040, 0
    s_sub_u32 s34, s34, s14
    s_mov_b32 m0, s50
    s_add_u32 s10, s50, 3072
    buffer_load_dwordx4 v16, s[44:47], s34 offen  lds
    buffer_load_dwordx4 v17, s[44:47], s34 offen offset:1024  lds
    buffer_load_dwordx4 v18, s[44:47], s34 offen offset:2048  lds
    s_mov_b32 m0, s10
    s_add_u32 s50, s50, 10240
    buffer_load_dwordx4 v19, s[44:47], s34 offen  lds
    buffer_load_dwordx4 v20, s[44:47], s34 offen offset:1024  lds
    s_add_u32 s34, s34, 40960
    s_cmp_ge_u32 s50, s51
    s_cselect_b32 s14, 61440, 0
    s_sub_u32 s50, s50, s14
    s_cmp_ge_u32 s34, s35
    s_cselect_b32 s14, 983040, 0
    s_sub_u32 s34, s34, s14
    s_waitcnt vmcnt(20)
    s_barrier
    s_mov_b32 s13, 9
L_wo_loop:
    s_waitcnt vmcnt(10)
    s_barrier
    s_mov_b32 m0, s50
    s_add_u32 s10, s50, 3072
    buffer_load_dwordx4 v16, s[44:47], s34 offen  lds
    buffer_load_dwordx4 v17, s[44:47], s34 offen offset:1024  lds
    buffer_load_dwordx4 v18, s[44:47], s34 offen offset:2048  lds
    s_mov_b32 m0, s10
    s_add_u32 s50, s50, 10240
    buffer_load_dwordx4 v19, s[44:47], s34 offen  lds
    buffer_load_dwordx4 v20, s[44:47], s34 offen offset:1024  lds
    s_add_u32 s34, s34, 40960
    s_cmp_ge_u32 s50, s51
    s_cselect_b32 s14, 61440, 0
    s_sub_u32 s50, s50, s14
    s_cmp_ge_u32 s34, s35
    s_cselect_b32 s14, 983040, 0
    s_sub_u32 s34, s34, s14
    s_mov_b32 m0, s50
    s_add_u32 s10, s50, 3072
    buffer_load_dwordx4 v16, s[44:47], s34 offen  lds
    buffer_load_dwordx4 v17, s[44:47], s34 offen offset:1024  lds
    buffer_load_dwordx4 v18, s[44:47], s34 offen offset:2048  lds
    s_mov_b32 m0, s10
    s_add_u32 s50, s50, 10240
    buffer_load_dwordx4 v19, s[44:47], s34 offen  lds
    buffer_load_dwordx4 v20, s[44:47], s34 offen offset:1024  lds
    s_add_u32 s34, s34, 40960
    s_cmp_ge_u32 s50, s51
    s_cselect_b32 s14, 61440, 0
    s_sub_u32 s50, s50, s14
    s_cmp_ge_u32 s34, s35
    s_cselect_b32 s14, 983040, 0
    s_sub_u32 s34, s34, s14
    s_sub_u32 s13, s13, 1
    s_cmp_lg_u32 s13, 0
    s_cbranch_scc1 L_wo_loop
    s_waitcnt vmcnt(10)
    s_barrier
    s_waitcnt vmcnt(0)
    s_barrier
    s_endpgm
L_ldx:
    v_lshrrev_b32 v7, 3, v2
    v_lshrrev_b32 v8, 1, v7
    v_and_b32 v9, 7, v2
    v_xor_b32 v8, v8, v9
    v_mul_u32_u24 v7, 1280, v7
    v_lshl_add_u32 v10, v8, 4, v7
    v_xor_b32 v11, 64, v10
    v_add_u32 v11, 9216, v11
    v_add_u32 v12, 18432, v10
    v_add_u32 v13, 18432, v11
    s_lshl_b32 s9, s61, 6
    s_mov_b32 s12, 143360
    s_mov_b32 s32, 159744
    s_mul_i32 s8, s5, 81920
    s_waitcnt lgkmcnt(0)
    s_add_u32 s36, s16, s8
    s_addc_u32 s37, s17, 0
    s_mov_b32 s38, 81920
    s_mov_b32 s39, 0x20000
    s_mov_b32 m0, s12
    s_add_u32 s10, s9, 40960
    buffer_load_dwordx4 v10, s[36:39], s9 offen  lds
    buffer_load_dwordx4 v11, s[36:39], s9 offen offset:1024  lds
    buffer_load_dwordx4 v12, s[36:39], s9 offen offset:2048  lds
    buffer_load_dwordx4 v13, s[36:39], s9 offen offset:3072  lds
    s_mov_b32 m0, s32
    s_add_u32 s9, s9, 128
    buffer_load_dwordx4 v10, s[36:39], s10 offen  lds
    buffer_load_dwordx4 v11, s[36:39], s10 offen offset:1024  lds
    buffer_load_dwordx4 v12, s[36:39], s10 offen offset:2048  lds
    buffer_load_dwordx4 v13, s[36:39], s10 offen offset:3072  lds
    s_add_u32 s12, s12, 32768
    s_cmp_ge_u32 s12, 163840
    s_cselect_b32 s14, 114688, 0
    s_sub_u32 s12, s12, s14
    s_add_u32 s32, s32, 32768
    s_cmp_ge_u32 s32, 163840
    s_cselect_b32 s14, 114688, 0
    s_sub_u32 s32, s32, s14
    s_cmp_ge_u32 s9, 1280
    s_cselect_b32 s14, 1280, 0
    s_sub_u32 s9, s9, s14
    s_mov_b32 m0, s12
    s_add_u32 s10, s9, 40960
    buffer_load_dwordx4 v10, s[36:39], s9 offen  lds
    buffer_load_dwordx4 v11, s[36:39], s9 offen offset:1024  lds
    buffer_load_dwordx4 v12, s[36:39], s9 offen offset:2048  lds
    buffer_load_dwordx4 v13, s[36:39], s9 offen offset:3072  lds
    s_mov_b32 m0, s32
    s_add_u32 s9, s9, 128
    buffer_load_dwordx4 v10, s[36:39], s10 offen  lds
    buffer_load_dwordx4 v11, s[36:39], s10 offen offset:1024  lds
    buffer_load_dwordx4 v12, s[36:39], s10 offen offset:2048  lds
    buffer_load_dwordx4 v13, s[36:39], s10 offen offset:3072  lds
    s_add_u32 s12, s12, 32768
    s_cmp_ge_u32 s12, 163840
    s_cselect_b32 s14, 114688, 0
    s_sub_u32 s12, s12, s14
    s_add_u32 s32, s32, 32768
    s_cmp_ge_u32 s32, 163840
    s_cselect_b32 s14, 114688, 0
    s_sub_u32 s32, s32, s14
    s_cmp_ge_u32 s9, 1280
    s_cselect_b32 s14, 1280, 0
    s_sub_u32 s9, s9, s14
    s_mov_b32 s13, 8
L_x_loop:
    s_waitcnt vmcnt(8)
    s_barrier
    s_mov_b32 m0, s12
    s_add_u32 s10, s9, 40960
    buffer_load_dwordx4 v10, s[36:39], s9 offen  lds
    buffer_load_dwordx4 v11, s[36:39], s9 offen offset:1024  lds
    buffer_load_dwordx4 v12, s[36:39], s9 offen offset:2048  lds
    buffer_load_dwordx4 v13, s[36:39], s9 offen offset:3072  lds
    s_mov_b32 m0, s32
    s_add_u32 s9, s9, 128
    buffer_load_dwordx4 v10, s[36:39], s10 offen  lds
    buffer_load_dwordx4 v11, s[36:39], s10 offen offset:1024  lds
    buffer_load_dwordx4 v12, s[36:39], s10 offen offset:2048  lds
    buffer_load_dwordx4 v13, s[36:39], s10 offen offset:3072  lds
    s_add_u32 s12, s12, 32768
    s_cmp_ge_u32 s12, 163840
    s_cselect_b32 s14, 114688, 0
    s_sub_u32 s12, s12, s14
    s_add_u32 s32, s32, 32768
    s_cmp_ge_u32 s32, 163840
    s_cselect_b32 s14, 114688, 0
    s_sub_u32 s32, s32, s14
    s_cmp_ge_u32 s9, 1280
    s_cselect_b32 s14, 1280, 0
    s_sub_u32 s9, s9, s14
    s_sub_u32 s13, s13, 1
    s_cmp_lg_u32 s13, 0
    s_cbranch_scc1 L_x_loop
    s_waitcnt vmcnt(8)
    s_barrier
    s_waitcnt vmcnt(0)
    s_barrier
    s_endpgm
L_ldkv:
    v_add_u32 v7, 0, v2
    v_mul_u32_u24 v8, 2731, v7
    v_lshrrev_b32 v8, 16, v8
    v_mul_u32_u24 v9, 24, v8
    v_sub_u32 v9, v7, v9
    v_and_b32 v7, 6, v8
    v_xor_b32 v9, v9, v7
    v_mul_u32_u24 v8, 384, v8
    v_lshl_add_u32 v10, v9, 4, v8
    v_add_u32 v7, 64, v2
    v_mul_u32_u24 v8, 2731, v7
    v_lshrrev_b32 v8, 16, v8
    v_mul_u32_u24 v9, 24, v8
    v_sub_u32 v9, v7, v9
    v_and_b32 v7, 6, v8
    v_xor_b32 v9, v9, v7
    v_mul_u32_u24 v8, 384, v8
    v_lshl_add_u32 v11, v9, 4, v8
    v_subrev_u32 v11, 1024, v11
    v_add_u32 v7, 128, v2
    v_mul_u32_u24 v8, 2731, v7
    v_lshrrev_b32 v8, 16, v8
    v_mul_u32_u24 v9, 24, v8
    v_sub_u32 v9, v7, v9
    v_and_b32 v7, 6, v8
    v_xor_b32 v9, v9, v7
    v_mul_u32_u24 v8, 384, v8
    v_lshl_add_u32 v12, v9, 4, v8
    v_subrev_u32 v12, 2048, v12
    s_waitcnt lgkmcnt(0)
    s_mov_b32 s56, s28
    s_mov_b32 s57, s29
    s_mov_b32 s58, 256
    s_mov_b32 s59, 0x20000
    s_cmp_lg_u32 s2, 0
    s_cbranch_scc1 L_kv_go
    s_memrealtime s[52:53]
    s_waitcnt lgkmcnt(0)
    s_or_b32 s52, s52, 1
    v_mov_b32 v60, 0
    v_mov_b32 v62, s52
    v_mov_b32 v63, s53
    s_mov_b64 exec, 1
    buffer_store_dwordx2 v[62:63], v60, s[56:59], 0 offen sc1
    s_mov_b64 exec, -1
L_kv_go:
    s_lshl_b32 s8, s5, 5
    s_add_u32 s8, s8, s6
    s_mul_i32 s8, s8, 24576
    s_add_u32 s40, s18, s8
    s_addc_u32 s41, s19, 0
    s_mov_b32 s42, 24576
    s_mov_b32 s43, 0x20000
    s_lshl_b32 s8, s5, 5
    s_lshl_b32 s9, s4, 2
    s_add_u32 s8, s8, s9
    s_add_u32 s8, s8, s94
    s_mul_i32 s8, s8, 24576
    s_add_u32 s44, s20, s8
    s_addc_u32 s45, s21, 0
    s_mov_b32 s46, 24576
    s_mov_b32 s47, 0x20000
    s_lshr_b32 s8, s2, 3
    s_mul_i32 s8, s8, 30720
    s_mul_i32 s9, s4, 983040
    s_add_u32 s8, s8, s9
    s_add_u32 s48, s24, s8
    s_addc_u32 s49, s25, 0
    s_mov_b32 s50, 30720
    s_mov_b32 s51, 0x20000
    v_lshlrev_b32 v14, 7, v2
    v_mov_b32 v60, 0
    s_barrier
    s_barrier
    s_barrier
    s_barrier
    s_barrier
    s_mov_b32 m0, 0
    s_movk_i32 s9, 0
    buffer_load_dwordx4 v10, s[40:43], s9 offen  lds
    buffer_load_dwordx4 v11, s[40:43], s9 offen offset:1024  lds
    buffer_load_dwordx4 v12, s[40:43], s9 offen offset:2048  lds
    s_mov_b32 m0, 3072
    s_movk_i32 s9, 3072
    buffer_load_dwordx4 v10, s[40:43], s9 offen  lds
    buffer_load_dwordx4 v11, s[40:43], s9 offen offset:1024  lds
    buffer_load_dwordx4 v12, s[40:43], s9 offen offset:2048  lds
    s_barrier
    s_mov_b32 m0, 6144
    s_movk_i32 s9, 6144
    buffer_load_dwordx4 v10, s[40:43], s9 offen  lds
    buffer_load_dwordx4 v11, s[40:43], s9 offen offset:1024  lds
    buffer_load_dwordx4 v12, s[40:43], s9 offen offset:2048  lds
    s_mov_b32 m0, 9216
    s_movk_i32 s9, 9216
    buffer_load_dwordx4 v10, s[40:43], s9 offen  lds
    buffer_load_dwordx4 v11, s[40:43], s9 offen offset:1024  lds
    buffer_load_dwordx4 v12, s[40:43], s9 offen offset:2048  lds
    s_barrier
    s_mov_b32 m0, 12288
    s_movk_i32 s9, 12288
    buffer_load_dwordx4 v10, s[40:43], s9 offen  lds
    buffer_load_dwordx4 v11, s[40:43], s9 offen offset:1024  lds
    buffer_load_dwordx4 v12, s[40:43], s9 offen offset:2048  lds
    s_mov_b32 m0, 15360
    s_movk_i32 s9, 15360
    buffer_load_dwordx4 v10, s[40:43], s9 offen  lds
    buffer_load_dwordx4 v11, s[40:43], s9 offen offset:1024  lds
    buffer_load_dwordx4 v12, s[40:43], s9 offen offset:2048  lds
    s_barrier
    s_mov_b32 m0, 18432
    s_movk_i32 s9, 18432
    buffer_load_dwordx4 v10, s[40:43], s9 offen  lds
    buffer_load_dwordx4 v11, s[40:43], s9 offen offset:1024  lds
    buffer_load_dwordx4 v12, s[40:43], s9 offen offset:2048  lds
    s_mov_b32 m0, 21504
    s_movk_i32 s9, 21504
    buffer_load_dwordx4 v10, s[40:43], s9 offen  lds
    buffer_load_dwordx4 v11, s[40:43], s9 offen offset:1024  lds
    buffer_load_dwordx4 v12, s[40:43], s9 offen offset:2048  lds
    buffer_load_dwordx2 v[62:63], v60, s[56:59], 0 offen sc1
    s_barrier
    s_mov_b32 m0, 24576
    s_movk_i32 s9, 0
    buffer_load_dwordx4 v10, s[44:47], s9 offen  lds
    buffer_load_dwordx4 v11, s[44:47], s9 offen offset:1024  lds
    buffer_load_dwordx4 v12, s[44:47], s9 offen offset:2048  lds
    s_mov_b32 m0, 27648
    s_movk_i32 s9, 3072
    buffer_load_dwordx4 v10, s[44:47], s9 offen  lds
    buffer_load_dwordx4 v11, s[44:47], s9 offen offset:1024  lds
    buffer_load_dwordx4 v12, s[44:47], s9 offen offset:2048  lds
    s_mov_b32 m0, 30720
    s_movk_i32 s9, 6144
    buffer_load_dwordx4 v10, s[44:47], s9 offen  lds
    buffer_load_dwordx4 v11, s[44:47], s9 offen offset:1024  lds
    buffer_load_dwordx4 v12, s[44:47], s9 offen offset:2048  lds
    s_waitcnt vmcnt(10)
    s_barrier
    s_movk_i32 s9, 0
    buffer_load_dword v70, v14, s[48:51], s9 offen
    s_movk_i32 s9, 8192
    buffer_load_dword v71, v14, s[48:51], s9 offen
    s_movk_i32 s9, 16384
    buffer_load_dword v72, v14, s[48:51], s9 offen
    s_movk_i32 s9, 24576
    buffer_load_dword v73, v14, s[48:51], s9 offen
    s_waitcnt vmcnt(13)
    s_mov_b32 s99, 0x40000
L_nonce:
    v_readfirstlane_b32 s52, v62
    s_sub_u32 s99, s99, 1
    s_cbranch_scc1 L_nonce_x
    s_cmp_lg_u32 s52, 0
    s_cbranch_scc1 L_nonce_x
    buffer_load_dwordx2 v[62:63], v60, s[56:59], 0 offen sc1
    s_waitcnt vmcnt(0)
    s_branch L_nonce
L_nonce_x:
    v_readfirstlane_b32 s53, v63
    s_mov_b32 s9, 0
    v_mov_b32 v60, s52
    v_mov_b32 v61, s53
    v_mov_b32 v62, s9
    v_mov_b32 v24, 159744
    s_mov_b64 exec, 1
    ds_write_b96 v24, v[60:62]
    s_mov_b64 exec, -1
    s_waitcnt lgkmcnt(0)
    s_barrier
    s_mov_b32 m0, 33792
    s_movk_i32 s9, 9216
    buffer_load_dwordx4 v10, s[44:47], s9 offen  lds
    buffer_load_dwordx4 v11, s[44:47], s9 offen offset:1024  lds
    buffer_load_dwordx4 v12, s[44:47], s9 offen offset:2048  lds
    s_mov_b32 m0, 36864
    s_movk_i32 s9, 12288
    buffer_load_dwordx4 v10, s[44:47], s9 offen  lds
    buffer_load_dwordx4 v11, s[44:47], s9 offen offset:1024  lds
    buffer_load_dwordx4 v12, s[44:47], s9 offen offset:2048  lds
    s_mov_b32 m0, 39936
    s_movk_i32 s9, 15360
    buffer_load_dwordx4 v10, s[44:47], s9 offen  lds
    buffer_load_dwordx4 v11, s[44:47], s9 offen offset:1024  lds
    buffer_load_dwordx4 v12, s[44:47], s9 offen offset:2048  lds
    s_mov_b32 m0, 43008
    s_movk_i32 s9, 18432
    buffer_load_dwordx4 v10, s[44:47], s9 offen  lds
    buffer_load_dwordx4 v11, s[44:47], s9 offen offset:1024  lds
    buffer_load_dwordx4 v12, s[44:47], s9 offen offset:2048  lds
    s_mov_b32 m0, 46080
    s_movk_i32 s9, 21504
    buffer_load_dwordx4 v10, s[44:47], s9 offen  lds
    buffer_load_dwordx4 v11, s[44:47], s9 offen offset:1024  lds
    buffer_load_dwordx4 v12, s[44:47], s9 offen offset:2048  lds
    s_lshl_b32 s8, s5, 5
    s_lshl_b32 s9, s4, 2
    s_add_u32 s8, s8, s9
    s_mul_i32 s10, s8, 24576
    s_add_u32 s44, s20, s10
    s_addc_u32 s45, s21, 0
    s_mov_b32 s46, 98304
    s_mov_b32 s47, 0x20000
    s_lshl_b32 s10, s8, 13
    s_add_u32 s10, s10, 0
    s_add_u32 s32, s30, s10
    s_addc_u32 s33, s31, 0
    s_mov_b32 s34, 32768
    s_mov_b32 s35, 0x20000
    s_lshl_b32 s8, s5, 3
    s_add_u32 s8, s8, s4
    s_lshl_b32 s8, s8, 7
    s_add_u32 s8, s8, 33554432
    s_add_u32 s40, s30, s8
    s_addc_u32 s41, s31, 0
    s_mov_b32 s42, 128
    s_mov_b32 s43, 0x20000
    v_lshlrev_b32 v16, 4, v2
    v_lshlrev_b32 v54, 3, v2
    s_add_u32 s8, s94, 1
    s_and_b32 s8, s8, 3
    s_mul_i32 s8, s8, 24576
    s_mov_b32 m0, 73728
    s_add_u32 s9, s8, 0
    buffer_load_dwordx4 v10, s[44:47], s9 offen lds
    buffer_load_dwordx4 v11, s[44:47], s9 offen offset:1024 lds
    buffer_load_dwordx4 v12, s[44:47], s9 offen offset:2048 lds
    s_mov_b32 m0, 76800
    s_add_u32 s9, s8, 3072
    buffer_load_dwordx4 v10, s[44:47], s9 offen lds
    buffer_load_dwordx4 v11, s[44:47], s9 offen offset:1024 lds
    buffer_load_dwordx4 v12, s[44:47], s9 offen offset:2048 lds
    s_mov_b32 m0, 79872
    s_add_u32 s9, s8, 6144
    buffer_load_dwordx4 v10, s[44:47], s9 offen lds
    buffer_load_dwordx4 v11, s[44:47], s9 offen offset:1024 lds
    buffer_load_dwordx4 v12, s[44:47], s9 offen offset:2048 lds
    s_mov_b32 m0, 82944
    s_add_u32 s9, s8, 9216
    buffer_load_dwordx4 v10, s[44:47], s9 offen lds
    buffer_load_dwordx4 v11, s[44:47], s9 offen offset:1024 lds
    buffer_load_dwordx4 v12, s[44:47], s9 offen offset:2048 lds
    s_mov_b32 m0, 86016
    s_add_u32 s9, s8, 12288
    buffer_load_dwordx4 v10, s[44:47], s9 offen lds
    buffer_load_dwordx4 v11, s[44:47], s9 offen offset:1024 lds
    buffer_load_dwordx4 v12, s[44:47], s9 offen offset:2048 lds
    s_mov_b32 m0, 89088
    s_add_u32 s9, s8, 15360
    buffer_load_dwordx4 v10, s[44:47], s9 offen lds
    buffer_load_dwordx4 v11, s[44:47], s9 offen offset:1024 lds
    buffer_load_dwordx4 v12, s[44:47], s9 offen offset:2048 lds
    s_mov_b32 m0, 92160
    s_add_u32 s9, s8, 18432
    buffer_load_dwordx4 v10, s[44:47], s9 offen lds
    buffer_load_dwordx4 v11, s[44:47], s9 offen offset:1024 lds
    buffer_load_dwordx4 v12, s[44:47], s9 offen offset:2048 lds
    s_mov_b32 m0, 95232
    s_add_u32 s9, s8, 21504
    buffer_load_dwordx4 v10, s[44:47], s9 offen lds
    buffer_load_dwordx4 v11, s[44:47], s9 offen offset:1024 lds
    buffer_load_dwordx4 v12, s[44:47], s9 offen offset:2048 lds
    s_waitcnt vmcnt(24)
    s_barrier
    s_add_u32 s8, s94, 2
    s_and_b32 s8, s8, 3
    s_mul_i32 s8, s8, 24576
    s_mov_b32 m0, 0
    s_add_u32 s9, s8, 0
    buffer_load_dwordx4 v10, s[44:47], s9 offen lds
    buffer_load_dwordx4 v11, s[44:47], s9 offen offset:1024 lds
    buffer_load_dwordx4 v12, s[44:47], s9 offen offset:2048 lds
    s_mov_b32 m0, 3072
    s_add_u32 s9, s8, 3072
    buffer_load_dwordx4 v10, s[44:47], s9 offen lds
    buffer_load_dwordx4 v11, s[44:47], s9 offen offset:1024 lds
    buffer_load_dwordx4 v12, s[44:47], s9 offen offset:2048 lds
    s_mov_b32 m0, 6144
    s_add_u32 s9, s8, 6144
    buffer_load_dwordx4 v10, s[44:47], s9 offen lds
    buffer_load_dwordx4 v11, s[44:47], s9 offen offset:1024 lds
    buffer_load_dwordx4 v12, s[44:47], s9 offen offset:2048 lds
    s_mov_b32 m0, 9216
    s_add_u32 s9, s8, 9216
    buffer_load_dwordx4 v10, s[44:47], s9 offen lds
    buffer_load_dwordx4 v11, s[44:47], s9 offen offset:1024 lds
    buffer_load_dwordx4 v12, s[44:47], s9 offen offset:2048 lds
    s_mov_b32 m0, 12288
    s_add_u32 s9, s8, 12288
    buffer_load_dwordx4 v10, s[44:47], s9 offen lds
    buffer_load_dwordx4 v11, s[44:47], s9 offen offset:1024 lds
    buffer_load_dwordx4 v12, s[44:47], s9 offen offset:2048 lds
    s_mov_b32 m0, 15360
    s_add_u32 s9, s8, 15360
    buffer_load_dwordx4 v10, s[44:47], s9 offen lds
    buffer_load_dwordx4 v11, s[44:47], s9 offen offset:1024 lds
    buffer_load_dwordx4 v12, s[44:47], s9 offen offset:2048 lds
    s_mov_b32 m0, 18432
    s_add_u32 s9, s8, 18432
    buffer_load_dwordx4 v10, s[44:47], s9 offen lds
    buffer_load_dwordx4 v11, s[44:47], s9 offen offset:1024 lds
    buffer_load_dwordx4 v12, s[44:47], s9 offen offset:2048 lds
    s_mov_b32 m0, 21504
    s_add_u32 s9, s8, 21504
    buffer_load_dwordx4 v10, s[44:47], s9 offen lds
    buffer_load_dwordx4 v11, s[44:47], s9 offen offset:1024 lds
    buffer_load_dwordx4 v12, s[44:47], s9 offen offset:2048 lds
    s_barrier
    s_barrier
    s_add_u32 s8, s94, 3
    s_and_b32 s8, s8, 3
    s_mul_i32 s8, s8, 24576
    s_mov_b32 m0, 49152
    s_add_u32 s9, s8, 0
    buffer_load_dwordx4 v10, s[44:47], s9 offen lds
    buffer_load_dwordx4 v11, s[44:47], s9 offen offset:1024 lds
    buffer_load_dwordx4 v12, s[44:47], s9 offen offset:2048 lds
    s_mov_b32 m0, 52224
    s_add_u32 s9, s8, 3072
    buffer_load_dwordx4 v10, s[44:47], s9 offen lds
    buffer_load_dwordx4 v11, s[44:47], s9 offen offset:1024 lds
    buffer_load_dwordx4 v12, s[44:47], s9 offen offset:2048 lds
    s_mov_b32 m0, 55296
    s_add_u32 s9, s8, 6144
    buffer_load_dwordx4 v10, s[44:47], s9 offen lds
    buffer_load_dwordx4 v11, s[44:47], s9 offen offset:1024 lds
    buffer_load_dwordx4 v12, s[44:47], s9 offen offset:2048 lds
    s_mov_b32 m0, 58368
    s_add_u32 s9, s8, 9216
    buffer_load_dwordx4 v10, s[44:47], s9 offen lds
    buffer_load_dwordx4 v11, s[44:47], s9 offen offset:1024 lds
    buffer_load_dwordx4 v12, s[44:47], s9 offen offset:2048 lds
    s_mov_b32 m0, 61440
    s_add_u32 s9, s8, 12288
    buffer_load_dwordx4 v10, s[44:47], s9 offen lds
    buffer_load_dwordx4 v11, s[44:47], s9 offen offset:1024 lds
    buffer_load_dwordx4 v12, s[44:47], s9 offen offset:2048 lds
    s_mov_b32 m0, 64512
    s_add_u32 s9, s8, 15360
    buffer_load_dwordx4 v10, s[44:47], s9 offen lds
    buffer_load_dwordx4 v11, s[44:47], s9 offen offset:1024 lds
    buffer_load_dwordx4 v12, s[44:47], s9 offen offset:2048 lds
    s_mov_b32 m0, 67584
    s_add_u32 s9, s8, 18432
    buffer_load_dwordx4 v10, s[44:47], s9 offen lds
    buffer_load_dwordx4 v11, s[44:47], s9 offen offset:1024 lds
    buffer_load_dwordx4 v12, s[44:47], s9 offen offset:2048 lds
    s_mov_b32 m0, 70656
    s_add_u32 s9, s8, 21504
    buffer_load_dwordx4 v10, s[44:47], s9 offen lds
    buffer_load_dwordx4 v11, s[44:47], s9 offen offset:1024 lds
    buffer_load_dwordx4 v12, s[44:47], s9 offen offset:2048 lds
    s_waitcnt vmcnt(48)
    s_barrier
    s_barrier
    s_barrier
    s_waitcnt vmcnt(24)
    s_barrier
    s_mov_b64 exec, 0xffff
    buffer_load_dwordx2 v[52:53], v54, s[40:43], 0 offen sc1
    s_mov_b64 exec, -1
    s_barrier
    s_barrier
    s_waitcnt vmcnt(0)
    s_barrier
    s_mov_b64 exec, 0xffff
    v_cmp_ne_u64 vcc, s[52:53], v[52:53]
    s_mov_b64 exec, -1
    s_mov_b32 s15, 0
    s_cbranch_vccnz L_p_late
    s_add_u32 s8, s94, 0
    s_and_b32 s8, s8, 3
    s_lshl_b32 s8, s8, 13
    s_mov_b32 m0, 24576
    s_add_u32 s9, s8, 0
    buffer_load_dwordx4 v16, s[32:35], s9 offen sc1 lds
    buffer_load_dwordx4 v16, s[32:35], s9 offen offset:1024 sc1 lds
    buffer_load_dwordx4 v16, s[32:35], s9 offen offset:2048 sc1 lds
    buffer_load_dwordx4 v16, s[32:35], s9 offen offset:3072 sc1 lds
    s_mov_b32 m0, 28672
    s_add_u32 s9, s8, 4096
    buffer_load_dwordx4 v16, s[32:35], s9 offen sc1 lds
    buffer_load_dwordx4 v16, s[32:35], s9 offen offset:1024 sc1 lds
    buffer_load_dwordx4 v16, s[32:35], s9 offen offset:2048 sc1 lds
    buffer_load_dwordx4 v16, s[32:35], s9 offen offset:3072 sc1 lds
    s_add_u32 s8, s94, 1
    s_and_b32 s8, s8, 3
    s_lshl_b32 s8, s8, 13
    s_mov_b32 m0, 32768
    s_add_u32 s9, s8, 0
    buffer_load_dwordx4 v16, s[32:35], s9 offen sc1 lds
    buffer_load_dwordx4 v16, s[32:35], s9 offen offset:1024 sc1 lds
    buffer_load_dwordx4 v16, s[32:35], s9 offen offset:2048 sc1 lds
    buffer_load_dwordx4 v16, s[32:35], s9 offen offset:3072 sc1 lds
    s_mov_b32 m0, 36864
    s_add_u32 s9, s8, 4096
    buffer_load_dwordx4 v16, s[32:35], s9 offen sc1 lds
    buffer_load_dwordx4 v16, s[32:35], s9 offen offset:1024 sc1 lds
    buffer_load_dwordx4 v16, s[32:35], s9 offen offset:2048 sc1 lds
    buffer_load_dwordx4 v16, s[32:35], s9 offen offset:3072 sc1 lds
    s_add_u32 s8, s94, 2
    s_and_b32 s8, s8, 3
    s_lshl_b32 s8, s8, 13
    s_mov_b32 m0, 40960
    s_add_u32 s9, s8, 0
    buffer_load_dwordx4 v16, s[32:35], s9 offen sc1 lds
    buffer_load_dwordx4 v16, s[32:35], s9 offen offset:1024 sc1 lds
    buffer_load_dwordx4 v16, s[32:35], s9 offen offset:2048 sc1 lds
    buffer_load_dwordx4 v16, s[32:35], s9 offen offset:3072 sc1 lds
    s_mov_b32 m0, 45056
    s_add_u32 s9, s8, 4096
    buffer_load_dwordx4 v16, s[32:35], s9 offen sc1 lds
    buffer_load_dwordx4 v16, s[32:35], s9 offen offset:1024 sc1 lds
    buffer_load_dwordx4 v16, s[32:35], s9 offen offset:2048 sc1 lds
    buffer_load_dwordx4 v16, s[32:35], s9 offen offset:3072 sc1 lds
    s_add_u32 s8, s94, 3
    s_and_b32 s8, s8, 3
    s_lshl_b32 s8, s8, 13
    s_mov_b32 m0, 73728
    s_add_u32 s9, s8, 0
    buffer_load_dwordx4 v16, s[32:35], s9 offen sc1 lds
    buffer_load_dwordx4 v16, s[32:35], s9 offen offset:1024 sc1 lds
    buffer_load_dwordx4 v16, s[32:35], s9 offen offset:2048 sc1 lds
    buffer_load_dwordx4 v16, s[32:35], s9 offen offset:3072 sc1 lds
    s_mov_b32 m0, 77824
    s_add_u32 s9, s8, 4096
    buffer_load_dwordx4 v16, s[32:35], s9 offen sc1 lds
    buffer_load_dwordx4 v16, s[32:35], s9 offen offset:1024 sc1 lds
    buffer_load_dwordx4 v16, s[32:35], s9 offen offset:2048 sc1 lds
    buffer_load_dwordx4 v16, s[32:35], s9 offen offset:3072 sc1 lds
    s_mov_b32 s15, 1
L_p_late:
    s_barrier
    s_barrier
    s_cmp_eq_u32 s15, 1
    s_cbranch_scc1 L_p_done
    s_mov_b64 exec, 0xffff
    s_mov_b32 s99, 0x40000
    buffer_load_dwordx2 v[52:53], v54, s[40:43], 0 offen sc1
    buffer_load_dwordx2 v[238:239], v54, s[40:43], 0 offen sc1
L_poll1:
    buffer_load_dwordx2 v[240:241], v54, s[40:43], 0 offen sc1
    s_waitcnt vmcnt(2)
    v_cmp_ne_u64 vcc, s[52:53], v[52:53]
    s_cbranch_vccz L_poll1_x
    buffer_load_dwordx2 v[52:53], v54, s[40:43], 0 offen sc1
    s_waitcnt vmcnt(2)
    v_cmp_ne_u64 vcc, s[52:53], v[238:239]
    s_cbranch_vccz L_poll1_x
    buffer_load_dwordx2 v[238:239], v54, s[40:43], 0 offen sc1
    s_waitcnt vmcnt(2)
    v_cmp_ne_u64 vcc, s[52:53], v[240:241]
    s_cbranch_vccz L_poll1_x
    s_sub_u32 s99, s99, 1
    s_cbranch_scc0 L_poll1
L_poll1_x:
    s_waitcnt vmcnt(0)
    s_mov_b64 exec, -1
    s_add_u32 s8, s94, 0
    s_and_b32 s8, s8, 3
    s_lshl_b32 s8, s8, 13
    s_mov_b32 m0, 24576
    s_add_u32 s9, s8, 0
    buffer_load_dwordx4 v16, s[32:35], s9 offen sc1 lds
    buffer_load_dwordx4 v16, s[32:35], s9 offen offset:1024 sc1 lds
    buffer_load_dwordx4 v16, s[32:35], s9 offen offset:2048 sc1 lds
    buffer_load_dwordx4 v16, s[32:35], s9 offen offset:3072 sc1 lds
    s_mov_b32 m0, 28672
    s_add_u32 s9, s8, 4096
    buffer_load_dwordx4 v16, s[32:35], s9 offen sc1 lds
    buffer_load_dwordx4 v16, s[32:35], s9 offen offset:1024 sc1 lds
    buffer_load_dwordx4 v16, s[32:35], s9 offen offset:2048 sc1 lds
    buffer_load_dwordx4 v16, s[32:35], s9 offen offset:3072 sc1 lds
    s_add_u32 s8, s94, 1
    s_and_b32 s8, s8, 3
    s_lshl_b32 s8, s8, 13
    s_mov_b32 m0, 32768
    s_add_u32 s9, s8, 0
    buffer_load_dwordx4 v16, s[32:35], s9 offen sc1 lds
    buffer_load_dwordx4 v16, s[32:35], s9 offen offset:1024 sc1 lds
    buffer_load_dwordx4 v16, s[32:35], s9 offen offset:2048 sc1 lds
    buffer_load_dwordx4 v16, s[32:35], s9 offen offset:3072 sc1 lds
    s_mov_b32 m0, 36864
    s_add_u32 s9, s8, 4096
    buffer_load_dwordx4 v16, s[32:35], s9 offen sc1 lds
    buffer_load_dwordx4 v16, s[32:35], s9 offen offset:1024 sc1 lds
    buffer_load_dwordx4 v16, s[32:35], s9 offen offset:2048 sc1 lds
    buffer_load_dwordx4 v16, s[32:35], s9 offen offset:3072 sc1 lds
    s_add_u32 s8, s94, 2
    s_and_b32 s8, s8, 3
    s_lshl_b32 s8, s8, 13
    s_mov_b32 m0, 40960
    s_add_u32 s9, s8, 0
    buffer_load_dwordx4 v16, s[32:35], s9 offen sc1 lds
    buffer_load_dwordx4 v16, s[32:35], s9 offen offset:1024 sc1 lds
    buffer_load_dwordx4 v16, s[32:35], s9 offen offset:2048 sc1 lds
    buffer_load_dwordx4 v16, s[32:35], s9 offen offset:3072 sc1 lds
    s_mov_b32 m0, 45056
    s_add_u32 s9, s8, 4096
    buffer_load_dwordx4 v16, s[32:35], s9 offen sc1 lds
    buffer_load_dwordx4 v16, s[32:35], s9 offen offset:1024 sc1 lds
    buffer_load_dwordx4 v16, s[32:35], s9 offen offset:2048 sc1 lds
    buffer_load_dwordx4 v16, s[32:35], s9 offen offset:3072 sc1 lds
    s_add_u32 s8, s94, 3
    s_and_b32 s8, s8, 3
    s_lshl_b32 s8, s8, 13
    s_mov_b32 m0, 73728
    s_add_u32 s9, s8, 0
    buffer_load_dwordx4 v16, s[32:35], s9 offen sc1 lds
    buffer_load_dwordx4 v16, s[32:35], s9 offen offset:1024 sc1 lds
    buffer_load_dwordx4 v16, s[32:35], s9 offen offset:2048 sc1 lds
    buffer_load_dwordx4 v16, s[32:35], s9 offen offset:3072 sc1 lds
    s_mov_b32 m0, 77824
    s_add_u32 s9, s8, 4096
    buffer_load_dwordx4 v16, s[32:35], s9 offen sc1 lds
    buffer_load_dwordx4 v16, s[32:35], s9 offen offset:1024 sc1 lds
    buffer_load_dwordx4 v16, s[32:35], s9 offen offset:2048 sc1 lds
    buffer_load_dwordx4 v16, s[32:35], s9 offen offset:3072 sc1 lds
L_p_done:
    s_waitcnt vmcnt(0)
    s_barrier
    s_endpgm
L_end:
    s_endpgm
.section .rodata,"a"
.p2align 6
.amdhsa_kernel standalone__mha_block_cached__near_ridge_kernel
  .amdhsa_next_free_vgpr 256
  .amdhsa_next_free_sgpr 100
  .amdhsa_accum_offset 256
  .amdhsa_group_segment_fixed_size 0
  .amdhsa_kernarg_size 64
  .amdhsa_user_sgpr_count 2
  .amdhsa_user_sgpr_kernarg_segment_ptr 1
  .amdhsa_system_sgpr_workgroup_id_x 1
.end_amdhsa_kernel
```
